```python
import torch

def _softmax(x, axis=-1):
    return torch.softmax(x, dim=axis)

def _gelu(x):
    return torch.nn.functional.gelu(x, approximate='tanh')

def _silu(x):
    return torch.nn.functional.silu(x)

def _sigmoid(x):
    return torch.sigmoid(x)

def _layernorm(x, axis=-1, eps=1e-05):
    m = x.mean(dim=axis, keepdim=True)
    v = x.var(dim=axis, keepdim=True, unbiased=False)
    return (x - m) / torch.sqrt(v + eps)

def _scatter_add(tgt, idx, src, axis=0):
    return tgt.clone().index_add_(axis, idx, src)

def _segment_sum(src, seg, n):
    out = torch.zeros((n,) + src.shape[1:], dtype=src.dtype)
    return out.index_add_(0, seg, src)

def _pad(x, pw):
    flat = tuple((v for pair in reversed(pw) for v in pair))
    return torch.nn.functional.pad(x, flat)
kernel_name = 'sequential_preLN__memory_aug_recurrent_mem_tr__glu_gated_swiglu__prompt'

def setup_inputs():

    _w = lambda a: (lambda t: t.to(torch.bfloat16) if t.is_floating_point() else t)(torch.as_tensor(a))

    def _A_setup():
        B, S, Dm = (1, 2048, 512)
        H, Dh = (32, 128)
        M, seg = (8, 32)
        seg = min(seg, S)
        S = S // seg * seg
        return {'x': _w((lambda *s: torch.randn(*s, dtype=torch.bfloat16) * 0.05)(B, S, Dm)), 'mem0': _w((lambda *s: torch.randn(*s, dtype=torch.bfloat16) * 0.2)(B, M, Dm)), 'Wq': _w((lambda *s: torch.randn(*s, dtype=torch.bfloat16) * 1.6)(Dm, H, Dh) * Dm ** (-0.5)), 'Wk': _w((lambda *s: torch.randn(*s, dtype=torch.bfloat16) * 1.6)(Dm, H, Dh) * Dm ** (-0.5)), 'Wv': _w((lambda *s: torch.randn(*s, dtype=torch.bfloat16) * 0.2)(Dm, H, Dh) * Dm ** (-0.5)), 'Wo': _w((lambda *s: torch.randn(*s, dtype=torch.bfloat16) * 0.2)(H, Dh, Dm) * (H * Dh) ** (-0.5)), 'seg_len': seg}
    _A_in = _A_setup()

    def _B_setup():
        B, S, D, F = (1, 2048, 512, 1376)
        return {'x': _w((lambda *s: torch.randn(*s, dtype=torch.bfloat16) * 0.05)(B, S, D)), 'w1': _w((lambda *s: torch.randn(*s, dtype=torch.bfloat16) * 0.2)(D, F) * (2.0 / D) ** 0.5), 'w3': _w((lambda *s: torch.randn(*s, dtype=torch.bfloat16) * 0.2)(D, F) * (2.0 / D) ** 0.5), 'w2': _w((lambda *s: torch.randn(*s, dtype=torch.bfloat16) * 0.2)(F, D) * (2.0 / F) ** 0.5)}
    _B_in = _B_setup()
    return {'A_x': _A_in['x'], 'A_mem0': _A_in['mem0'], 'A_Wq': _A_in['Wq'], 'A_Wk': _A_in['Wk'], 'A_Wv': _A_in['Wv'], 'A_Wo': _A_in['Wo'], 'A_seg_len': _A_in['seg_len'], 'B_x': _B_in['x'], 'B_w1': _B_in['w1'], 'B_w3': _B_in['w3'], 'B_w2': _B_in['w2']}

def reference(A_x, A_mem0, A_Wq, A_Wk, A_Wv, A_Wo, A_seg_len, B_x, B_w1, B_w3, B_w2):

    def _A_ref(x, mem0, Wq, Wk, Wv, Wo, seg_len):
        B, S, Dm = x.shape
        H, Dh = (Wq.shape[1], Wq.shape[2])
        M = mem0.shape[1]
        scale = Dh ** (-0.5)
        n_seg = S // seg_len
        L = M + seg_len
        idx = torch.arange(L)
        mask = (idx[:, None] < M) | (idx[:, None] >= idx[None, :])
        mem = mem0
        outs = []
        for s in range(n_seg):
            xs = x[:, s * seg_len:(s + 1) * seg_len, :].clone()
            h = torch.concatenate([mem, xs], axis=1)
            q = torch.einsum('btd,dhe->bhte', h, Wq)
            k = torch.einsum('btd,dhe->bhte', h, Wk)
            v = torch.einsum('btd,dhe->bhte', h, Wv)
            scores = torch.einsum('bhqe,bhke->bhqk', q, k) * scale
            scores = torch.where(mask[None, None], scores, -1000000000.0)
            p = _softmax(scores, axis=-1)
            o = torch.einsum('bhqk,bhke->bhqe', p, v)
            o = torch.einsum('bhte,hed->btd', o, Wo)
            mem = o[:, :M, :].clone()
            outs.append(o[:, M:, :])
        return torch.concatenate(outs, axis=1)

    def _B_ref(x, w1, w3, w2):
        gate = torch.einsum('bsd,df->bsf', x, w1)
        up = torch.einsum('bsd,df->bsf', x, w3)
        h = _silu(gate) * up
        out = torch.einsum('bsf,fd->bsd', h, w2)
        return out
    x = A_x
    h = x + _A_ref(_layernorm(x, axis=-1), A_mem0, A_Wq, A_Wk, A_Wv, A_Wo, A_seg_len)
    h2 = h + _B_ref(_layernorm(h, axis=-1), B_w1, B_w3, B_w2)
    return h2
```

```asm
; @launch grid=(256,1,1) block=(256,1,1) lds=163840
.amdgcn_target "amdgcn-amd-amdhsa--gfx950"
.text
.globl sequential_preLN__memory_aug_recurrent_mem_tr__glu_gated_swiglu__prompt_kernel
.p2align 8
.type sequential_preLN__memory_aug_recurrent_mem_tr__glu_gated_swiglu__prompt_kernel,@function
sequential_preLN__memory_aug_recurrent_mem_tr__glu_gated_swiglu__prompt_kernel:
  s_cmp_ge_u32 s2, 256
  s_cbranch_scc1 END_1
  s_load_dwordx2 s[8:9], s[0:1], 104
  s_load_dwordx2 s[24:25], s[0:1], 96
  v_and_b32 v1, 63, v0
  v_lshrrev_b32 v2, 6, v0
  s_nop 0
  v_readfirstlane_b32 s4, v2
  s_mov_b32 s6, 400000
  s_getreg_b32 s54, hwreg(HW_REG_XCC_ID)
  s_and_b32 s54, s54, 7
  s_add_u32 s54, s54, 1
  s_mov_b32 s3, s2
  s_mov_b32 s101, 0
  s_or_b32 s44, s2, s4
  s_cmp_lg_u32 s44, 0
  s_cbranch_scc1 ROLED_3
  s_waitcnt lgkmcnt(0)
  s_and_b32 s25, s25, 0xffff
  s_mov_b32 s26, 0x100
  s_mov_b32 s27, 0x20000
  v_mov_b32 v2, 0
  v_mov_b32 v3, s54
  buffer_store_dword v3, v2, s[24:27], 0 offen offset:228 sc1
ROLED_3:
  s_and_b32 s5, s3, 7
  s_lshl_b32 s5, s5, 5
  s_lshr_b32 s3, s3, 3
  s_add_u32 s5, s5, s3
  s_cmp_ge_u32 s5, 32
  s_cbranch_scc1 WORK_4
  s_load_dwordx2 s[12:13], s[0:1], 16
  s_load_dwordx2 s[16:17], s[0:1], 24
  s_load_dwordx2 s[20:21], s[0:1], 32
  s_load_dwordx2 s[28:29], s[0:1], 40
  s_load_dwordx2 s[56:57], s[0:1], 8
  v_and_b32 v90, 15, v1
  v_lshrrev_b32 v91, 4, v1
  s_and_b32 s44, s4, 1
  s_lshl_b32 s44, s44, 2
  v_xor_b32 v120, s44, v90
  v_and_b32 v121, 1, v91
  v_lshlrev_b32 v121, 3, v121
  v_xor_b32 v120, v120, v121
  v_lshlrev_b32 v120, 4, v120
  v_lshl_add_u32 v120, v91, 13, v120
  s_lshl_b32 s45, s5, 8
  s_lshl_b32 s48, s4, 17
  s_add_u32 s45, s45, s48
  s_lshl_b32 s44, s4, 12
  s_waitcnt lgkmcnt(0)
  s_and_b32 s13, s13, 0xffff
  s_mov_b32 s14, 0x400000
  s_mov_b32 s15, 0x20000
  s_add_u32 s48, s45, 0
  s_add_u32 m0, s44, 0
  s_nop 0
  buffer_load_dwordx4 v120, s[12:15], s48 offen lds
  s_add_u32 s48, s45, 32768
  s_add_u32 m0, s44, 1024
  s_nop 0
  buffer_load_dwordx4 v120, s[12:15], s48 offen lds
  s_add_u32 s48, s45, 65536
  s_add_u32 m0, s44, 2048
  s_nop 0
  buffer_load_dwordx4 v120, s[12:15], s48 offen lds
  s_add_u32 s48, s45, 98304
  s_add_u32 m0, s44, 3072
  s_nop 0
  buffer_load_dwordx4 v120, s[12:15], s48 offen lds
  s_add_u32 s48, s45, 1048576
  s_add_u32 m0, s44, 16384
  s_nop 0
  buffer_load_dwordx4 v120, s[12:15], s48 offen lds
  s_add_u32 s48, s45, 1081344
  s_add_u32 m0, s44, 17408
  s_nop 0
  buffer_load_dwordx4 v120, s[12:15], s48 offen lds
  s_add_u32 s48, s45, 1114112
  s_add_u32 m0, s44, 18432
  s_nop 0
  buffer_load_dwordx4 v120, s[12:15], s48 offen lds
  s_add_u32 s48, s45, 1146880
  s_add_u32 m0, s44, 19456
  s_nop 0
  buffer_load_dwordx4 v120, s[12:15], s48 offen lds
  s_add_u32 s48, s45, 2097152
  s_add_u32 m0, s44, 32768
  s_nop 0
  buffer_load_dwordx4 v120, s[12:15], s48 offen lds
  s_add_u32 s48, s45, 2129920
  s_add_u32 m0, s44, 33792
  s_nop 0
  buffer_load_dwordx4 v120, s[12:15], s48 offen lds
  s_add_u32 s48, s45, 2162688
  s_add_u32 m0, s44, 34816
  s_nop 0
  buffer_load_dwordx4 v120, s[12:15], s48 offen lds
  s_add_u32 s48, s45, 2195456
  s_add_u32 m0, s44, 35840
  s_nop 0
  buffer_load_dwordx4 v120, s[12:15], s48 offen lds
  s_add_u32 s48, s45, 3145728
  s_add_u32 m0, s44, 49152
  s_nop 0
  buffer_load_dwordx4 v120, s[12:15], s48 offen lds
  s_add_u32 s48, s45, 3178496
  s_add_u32 m0, s44, 50176
  s_nop 0
  buffer_load_dwordx4 v120, s[12:15], s48 offen lds
  s_add_u32 s48, s45, 3211264
  s_add_u32 m0, s44, 51200
  s_nop 0
  buffer_load_dwordx4 v120, s[12:15], s48 offen lds
  s_add_u32 s48, s45, 3244032
  s_add_u32 m0, s44, 52224
  s_nop 0
  buffer_load_dwordx4 v120, s[12:15], s48 offen lds
  s_and_b32 s17, s17, 0xffff
  s_mov_b32 s18, 0x400000
  s_mov_b32 s19, 0x20000
  s_and_b32 s21, s21, 0xffff
  s_mov_b32 s22, 0x400000
  s_mov_b32 s23, 0x20000
  s_and_b32 s29, s29, 0xffff
  s_mov_b32 s30, 0x400000
  s_mov_b32 s31, 0x20000
  s_and_b32 s57, s57, 0xffff
  s_mov_b32 s58, 0x2000
  s_mov_b32 s59, 0x20000
  s_and_b32 s9, s9, 0xffff
  s_mov_b32 s10, 0x10000000
  s_mov_b32 s11, 0x20000
  s_and_b32 s25, s25, 0xffff
  s_mov_b32 s26, 0x100
  s_mov_b32 s27, 0x20000
  v_lshlrev_b32 v11, 4, v1
  s_xor_b32 s43, s4, 0
  s_lshl_b32 s43, s43, 11
  s_add_u32 s43, s43, 147456
  v_add_u32 v2, s43, v11
  s_xor_b32 s43, s4, 1
  s_lshl_b32 s43, s43, 11
  s_add_u32 s43, s43, 147456
  v_add_u32 v3, s43, v11
  s_xor_b32 s43, s4, 2
  s_lshl_b32 s43, s43, 11
  s_add_u32 s43, s43, 147456
  v_add_u32 v4, s43, v11
  s_xor_b32 s43, s4, 3
  s_lshl_b32 s43, s43, 11
  s_add_u32 s43, s43, 147456
  v_add_u32 v5, s43, v11
  v_and_b32 v90, 15, v1
  v_lshrrev_b32 v91, 4, v1
  v_bfe_u32 v92, v1, 2, 2
  v_and_b32 v93, 3, v1
  v_mul_u32_u24 v94, 320, v91
  v_lshl_add_u32 v94, v90, 3, v94
  s_mul_i32 s43, s4, 1280
  s_add_u32 s43, s43, 155648
  v_add_u32 v6, s43, v94
  s_lshr_b32 s43, s4, 1
  s_mul_i32 s43, s43, 1280
  s_and_b32 s42, s4, 1
  s_lshl_b32 s42, s42, 7
  s_add_u32 s43, s43, s42
  s_add_u32 s43, s43, 160768
  v_add_u32 v8, s43, v94
  v_mul_u32_u24 v94, 320, v93
  v_lshrrev_b32 v95, 2, v1
  v_lshl_add_u32 v94, v95, 3, v94
  v_add_u32 v7, 155648, v94
  s_lshl_b32 s43, s4, 14
  v_add_u32 v9, s43, v11
  v_add_u32 v13, 0x10000, v9
  v_add_u32 v10, 131072, v11
  v_lshlrev_b32 v94, 14, v91
  v_lshl_add_u32 v12, v90, 3, v94
  v_lshlrev_b32 v94, 4, v91
  v_lshl_add_u32 v94, v93, 2, v94
  v_lshl_add_u32 v94, v92, 8, v94
  v_and_b32 v95, 8, v1
  v_cmp_eq_u32 vcc, 0, v95
  v_mov_b32 v95, 0x40000000
  s_nop 0
  v_cndmask_b32 v14, v95, v94, vcc
  v_and_b32 v94, 2, v1
  v_cmp_eq_u32 vcc, 0, v94
  v_mov_b32 v94, 0x44444444
  v_mov_b32 v95, 0xeeeeeeee
  v_cndmask_b32 v15, v95, v94, vcc
  v_mov_b32 v94, 0x3f80
  v_mov_b32 v95, 0x3f800000
  v_cmp_eq_u32 vcc, 0, v90
  s_nop 1
  v_cndmask_b32 v20, 0, v94, vcc
  v_cmp_eq_u32 vcc, 1, v90
  s_nop 1
  v_cndmask_b32 v20, v20, v95, vcc
  v_cmp_eq_u32 vcc, 4, v90
  s_nop 1
  v_cndmask_b32 v21, 0, v94, vcc
  v_cmp_eq_u32 vcc, 5, v90
  s_nop 1
  v_cndmask_b32 v21, v21, v95, vcc
  v_cmp_eq_u32 vcc, 8, v90
  s_nop 1
  v_cndmask_b32 v22, 0, v94, vcc
  v_cmp_eq_u32 vcc, 9, v90
  s_nop 1
  v_cndmask_b32 v22, v22, v95, vcc
  v_cmp_eq_u32 vcc, 12, v90
  s_nop 1
  v_cndmask_b32 v23, 0, v94, vcc
  v_cmp_eq_u32 vcc, 13, v90
  s_nop 1
  v_cndmask_b32 v23, v23, v95, vcc
  s_lshl_b32 s43, s4, 16
  s_lshl_b32 s32, s5, 7
  s_add_u32 s32, s32, s43
  s_add_u32 s32, s32, 0x7000000
  s_add_u32 s33, s32, 0x1000
  s_lshl_b32 s34, s5, 2
  s_add_u32 s34, s34, s4
  s_lshl_b32 s34, s34, 11
  s_add_u32 s34, s34, 0x7000000
  s_lshr_b32 s35, s5, 3
  s_lshl_b32 s35, s35, 11
  s_and_b32 s43, s5, 1
  s_lshl_b32 s43, s43, 9
  s_add_u32 s35, s35, s43
  s_bfe_u32 s43, s5, 0x20001
  s_lshl_b32 s43, s43, 6
  s_add_u32 s35, s35, s43
  s_and_b32 s43, s4, 1
  s_lshl_b32 s43, s43, 10
  s_add_u32 s35, s35, s43
  s_add_u32 s35, s35, 0x7100000
  s_lshl_b32 s36, s4, 11
  s_add_u32 s36, s36, 0x7100000
  s_lshl_b32 s37, s5, 13
  s_lshl_b32 s43, s4, 11
  s_add_u32 s37, s37, s43
  s_add_u32 s40, s37, 0x2200000
  s_add_u32 s37, s37, 0x1200000
  s_add_u32 s38, s43, 131072
  s_lshl_b32 s39, s5, 12
  s_lshl_b32 s43, s4, 10
  s_add_u32 s39, s39, s43
  s_add_u32 s39, s39, 0x3200000
  s_mov_b32 s41, 0x3e0293ee
  s_mov_b32 s6, 400000
  s_mov_b32 s52, 0x33333333
  s_mov_b32 s53, 0x33333333
  s_mov_b32 s50, 0
  s_xor_b32 s51, s35, 0x2000
  s_lshl_b32 s46, s5, 7
  s_add_u32 s46, s46, 0x7201000
  s_lshl_b32 s47, s5, 7
  s_add_u32 s47, s47, 0x7202000
  v_lshlrev_b32 v0, 2, v93
  s_mov_b32 s7, 0
  v_lshrrev_b32 v121, 3, v1
  v_lshlrev_b32 v121, 10, v121
  v_and_b32 v122, 7, v1
  v_lshl_add_u32 v121, v122, 4, v121
  v_and_b32 v126, 1, v92
  v_lshl_add_u32 v126, v126, 2, v91
  v_lshrrev_b32 v127, 1, v92
  v_lshl_add_u32 v126, v126, 2, v127
  v_lshlrev_b32 v126, 8, v126
  v_xor_b32 v127, s4, v92
  v_lshl_add_u32 v126, v127, 6, v126
  v_lshl_add_u32 v126, v93, 4, v126
  s_xor_b32 s48, s4, 0
  s_lshl_b32 s48, s48, 14
  v_add_u32 v122, s48, v126
  s_xor_b32 s48, s4, 1
  s_lshl_b32 s48, s48, 14
  v_add_u32 v123, s48, v126
  s_xor_b32 s48, s4, 2
  s_lshl_b32 s48, s48, 14
  v_add_u32 v124, s48, v126
  s_xor_b32 s48, s4, 3
  s_lshl_b32 s48, s48, 14
  v_add_u32 v125, s48, v126
  v_lshrrev_b32 v126, 1, v92
  v_lshrrev_b32 v127, 1, v91
  v_lshl_add_u32 v126, v127, 1, v126
  v_and_b32 v127, 1, v91
  v_lshl_add_u32 v126, v127, 3, v126
  v_lshlrev_b32 v126, 2, v126
  v_and_b32 v127, 1, v92
  v_add_u32 v126, v126, v127
  v_lshlrev_b32 v126, 7, v126
  v_lshl_add_u32 v126, v93, 3, v126
  s_lshl_b32 s48, s4, 14
  s_add_u32 s3, s48, 0x10000
  v_add_u32 v126, s3, v126
  s_lshl_b32 s49, s5, 17
  s_lshl_b32 s48, s4, 8
  s_add_u32 s49, s49, s48
  v_mov_b32 v96, -1
  v_mov_b32 v97, -1
  v_mov_b32 v98, -1
  v_mov_b32 v99, -1
  s_add_u32 s43, s34, 0x0
  buffer_store_dwordx4 v[96:99], v11, s[8:11], s43 offen sc1
  buffer_store_dwordx4 v[96:99], v11, s[8:11], s43 offen offset:1024 sc1
  s_add_u32 s43, s34, 0x40000
  buffer_store_dwordx4 v[96:99], v11, s[8:11], s43 offen sc1
  buffer_store_dwordx4 v[96:99], v11, s[8:11], s43 offen offset:1024 sc1
  buffer_store_dword v96, v14, s[8:11], s51 offen sc1
  v_lshrrev_b32 v104, 1, v90
  v_and_b32 v104, 6, v104
  v_and_b32 v105, 1, v1
  v_add_u32 v104, v104, v105
  v_lshlrev_b32 v104, 10, v104
  v_lshrrev_b32 v105, 1, v91
  v_lshl_add_u32 v104, v105, 6, v104
  v_and_b32 v105, 1, v91
  v_lshl_add_u32 v104, v105, 4, v104
  s_lshl_b32 s43, s4, 8
  buffer_load_dwordx4 v[40:43], v104, s[56:59], s43 offen offset:0
  buffer_load_dwordx4 v[44:47], v104, s[56:59], s43 offen offset:32
  buffer_load_dwordx4 v[48:51], v104, s[56:59], s43 offen offset:128
  buffer_load_dwordx4 v[52:55], v104, s[56:59], s43 offen offset:160
  v_mov_b32 v107, 0
  buffer_load_dword v118, v107, s[24:27], 0 offen offset:228 sc1
  s_add_u32 s48, s45, 524288
  s_add_u32 m0, s44, 65536
  s_nop 0
  buffer_load_dwordx4 v120, s[12:15], s48 offen lds
  s_add_u32 s48, s45, 557056
  s_add_u32 m0, s44, 66560
  s_nop 0
  buffer_load_dwordx4 v120, s[12:15], s48 offen lds
  s_add_u32 s48, s45, 589824
  s_add_u32 m0, s44, 67584
  s_nop 0
  buffer_load_dwordx4 v120, s[12:15], s48 offen lds
  s_add_u32 s48, s45, 622592
  s_add_u32 m0, s44, 68608
  s_nop 0
  buffer_load_dwordx4 v120, s[12:15], s48 offen lds
  s_add_u32 s48, s45, 1572864
  s_add_u32 m0, s44, 81920
  s_nop 0
  buffer_load_dwordx4 v120, s[12:15], s48 offen lds
  s_add_u32 s48, s45, 1605632
  s_add_u32 m0, s44, 82944
  s_nop 0
  buffer_load_dwordx4 v120, s[12:15], s48 offen lds
  s_add_u32 s48, s45, 1638400
  s_add_u32 m0, s44, 83968
  s_nop 0
  buffer_load_dwordx4 v120, s[12:15], s48 offen lds
  s_add_u32 s48, s45, 1671168
  s_add_u32 m0, s44, 84992
  s_nop 0
  buffer_load_dwordx4 v120, s[12:15], s48 offen lds
  s_add_u32 s48, s45, 2621440
  s_add_u32 m0, s44, 98304
  s_nop 0
  buffer_load_dwordx4 v120, s[12:15], s48 offen lds
  s_add_u32 s48, s45, 2654208
  s_add_u32 m0, s44, 99328
  s_nop 0
  buffer_load_dwordx4 v120, s[12:15], s48 offen lds
  s_add_u32 s48, s45, 2686976
  s_add_u32 m0, s44, 100352
  s_nop 0
  buffer_load_dwordx4 v120, s[12:15], s48 offen lds
  s_add_u32 s48, s45, 2719744
  s_add_u32 m0, s44, 101376
  s_nop 0
  buffer_load_dwordx4 v120, s[12:15], s48 offen lds
  s_add_u32 s48, s45, 3670016
  s_add_u32 m0, s44, 114688
  s_nop 0
  buffer_load_dwordx4 v120, s[12:15], s48 offen lds
  s_add_u32 s48, s45, 3702784
  s_add_u32 m0, s44, 115712
  s_nop 0
  buffer_load_dwordx4 v120, s[12:15], s48 offen lds
  s_add_u32 s48, s45, 3735552
  s_add_u32 m0, s44, 116736
  s_nop 0
  buffer_load_dwordx4 v120, s[12:15], s48 offen lds
  s_add_u32 s48, s45, 3768320
  s_add_u32 m0, s44, 117760
  s_nop 0
  buffer_load_dwordx4 v120, s[12:15], s48 offen lds
  s_waitcnt vmcnt(26)
  s_barrier
  ds_read_b64_tr_b16 a[0:1], v122 offset:0
  ds_read_b64_tr_b16 a[2:3], v122 offset:512
  ds_read_b64_tr_b16 a[4:5], v122 offset:8192
  ds_read_b64_tr_b16 a[6:7], v122 offset:8704
  ds_read_b64_tr_b16 a[64:65], v122 offset:8
  ds_read_b64_tr_b16 a[66:67], v122 offset:520
  ds_read_b64_tr_b16 a[68:69], v122 offset:8200
  ds_read_b64_tr_b16 a[70:71], v122 offset:8712
  s_waitcnt lgkmcnt(4)
  ds_read_b64_tr_b16 a[16:17], v123 offset:0
  ds_read_b64_tr_b16 a[18:19], v123 offset:512
  ds_read_b64_tr_b16 a[20:21], v123 offset:8192
  ds_read_b64_tr_b16 a[22:23], v123 offset:8704
  ds_read_b64_tr_b16 a[80:81], v123 offset:8
  ds_read_b64_tr_b16 a[82:83], v123 offset:520
  ds_read_b64_tr_b16 a[84:85], v123 offset:8200
  ds_read_b64_tr_b16 a[86:87], v123 offset:8712
  s_waitcnt lgkmcnt(4)
  ds_read_b64_tr_b16 a[32:33], v124 offset:0
  ds_read_b64_tr_b16 a[34:35], v124 offset:512
  ds_read_b64_tr_b16 a[36:37], v124 offset:8192
  ds_read_b64_tr_b16 a[38:39], v124 offset:8704
  ds_read_b64_tr_b16 a[96:97], v124 offset:8
  ds_read_b64_tr_b16 a[98:99], v124 offset:520
  ds_read_b64_tr_b16 a[100:101], v124 offset:8200
  ds_read_b64_tr_b16 a[102:103], v124 offset:8712
  s_waitcnt lgkmcnt(4)
  ds_read_b64_tr_b16 a[48:49], v125 offset:0
  ds_read_b64_tr_b16 a[50:51], v125 offset:512
  ds_read_b64_tr_b16 a[52:53], v125 offset:8192
  ds_read_b64_tr_b16 a[54:55], v125 offset:8704
  ds_read_b64_tr_b16 a[112:113], v125 offset:8
  ds_read_b64_tr_b16 a[114:115], v125 offset:520
  ds_read_b64_tr_b16 a[116:117], v125 offset:8200
  ds_read_b64_tr_b16 a[118:119], v125 offset:8712
  s_waitcnt lgkmcnt(4)
  v_xor_b32 v122, 0x10000, v122
  v_xor_b32 v123, 0x10000, v123
  v_xor_b32 v124, 0x10000, v124
  v_xor_b32 v125, 0x10000, v125
  s_waitcnt lgkmcnt(0)
  s_barrier
  s_add_u32 s48, s45, 0
  s_add_u32 m0, s44, 0
  s_nop 0
  buffer_load_dwordx4 v120, s[16:19], s48 offen lds
  s_add_u32 s48, s45, 32768
  s_add_u32 m0, s44, 1024
  s_nop 0
  buffer_load_dwordx4 v120, s[16:19], s48 offen lds
  s_add_u32 s48, s45, 65536
  s_add_u32 m0, s44, 2048
  s_nop 0
  buffer_load_dwordx4 v120, s[16:19], s48 offen lds
  s_add_u32 s48, s45, 98304
  s_add_u32 m0, s44, 3072
  s_nop 0
  buffer_load_dwordx4 v120, s[16:19], s48 offen lds
  s_add_u32 s48, s45, 1048576
  s_add_u32 m0, s44, 16384
  s_nop 0
  buffer_load_dwordx4 v120, s[16:19], s48 offen lds
  s_add_u32 s48, s45, 1081344
  s_add_u32 m0, s44, 17408
  s_nop 0
  buffer_load_dwordx4 v120, s[16:19], s48 offen lds
  s_add_u32 s48, s45, 1114112
  s_add_u32 m0, s44, 18432
  s_nop 0
  buffer_load_dwordx4 v120, s[16:19], s48 offen lds
  s_add_u32 s48, s45, 1146880
  s_add_u32 m0, s44, 19456
  s_nop 0
  buffer_load_dwordx4 v120, s[16:19], s48 offen lds
  s_add_u32 s48, s45, 2097152
  s_add_u32 m0, s44, 32768
  s_nop 0
  buffer_load_dwordx4 v120, s[16:19], s48 offen lds
  s_add_u32 s48, s45, 2129920
  s_add_u32 m0, s44, 33792
  s_nop 0
  buffer_load_dwordx4 v120, s[16:19], s48 offen lds
  s_add_u32 s48, s45, 2162688
  s_add_u32 m0, s44, 34816
  s_nop 0
  buffer_load_dwordx4 v120, s[16:19], s48 offen lds
  s_add_u32 s48, s45, 2195456
  s_add_u32 m0, s44, 35840
  s_nop 0
  buffer_load_dwordx4 v120, s[16:19], s48 offen lds
  s_add_u32 s48, s45, 3145728
  s_add_u32 m0, s44, 49152
  s_nop 0
  buffer_load_dwordx4 v120, s[16:19], s48 offen lds
  s_add_u32 s48, s45, 3178496
  s_add_u32 m0, s44, 50176
  s_nop 0
  buffer_load_dwordx4 v120, s[16:19], s48 offen lds
  s_add_u32 s48, s45, 3211264
  s_add_u32 m0, s44, 51200
  s_nop 0
  buffer_load_dwordx4 v120, s[16:19], s48 offen lds
  s_add_u32 s48, s45, 3244032
  s_add_u32 m0, s44, 52224
  s_nop 0
  buffer_load_dwordx4 v120, s[16:19], s48 offen lds
  buffer_load_dword v108, v107, s[24:27], 0 offen offset:224 sc1
  s_waitcnt vmcnt(17)
  s_barrier
  ds_read_b64_tr_b16 a[8:9], v122 offset:0
  ds_read_b64_tr_b16 a[10:11], v122 offset:512
  ds_read_b64_tr_b16 a[12:13], v122 offset:8192
  ds_read_b64_tr_b16 a[14:15], v122 offset:8704
  ds_read_b64_tr_b16 a[72:73], v122 offset:8
  ds_read_b64_tr_b16 a[74:75], v122 offset:520
  ds_read_b64_tr_b16 a[76:77], v122 offset:8200
  ds_read_b64_tr_b16 a[78:79], v122 offset:8712
  s_waitcnt lgkmcnt(4)
  ds_read_b64_tr_b16 a[24:25], v123 offset:0
  ds_read_b64_tr_b16 a[26:27], v123 offset:512
  ds_read_b64_tr_b16 a[28:29], v123 offset:8192
  ds_read_b64_tr_b16 a[30:31], v123 offset:8704
  ds_read_b64_tr_b16 a[88:89], v123 offset:8
  ds_read_b64_tr_b16 a[90:91], v123 offset:520
  ds_read_b64_tr_b16 a[92:93], v123 offset:8200
  ds_read_b64_tr_b16 a[94:95], v123 offset:8712
  s_waitcnt lgkmcnt(4)
  ds_read_b64_tr_b16 a[40:41], v124 offset:0
  ds_read_b64_tr_b16 a[42:43], v124 offset:512
  ds_read_b64_tr_b16 a[44:45], v124 offset:8192
  ds_read_b64_tr_b16 a[46:47], v124 offset:8704
  ds_read_b64_tr_b16 a[104:105], v124 offset:8
  ds_read_b64_tr_b16 a[106:107], v124 offset:520
  ds_read_b64_tr_b16 a[108:109], v124 offset:8200
  ds_read_b64_tr_b16 a[110:111], v124 offset:8712
  s_waitcnt lgkmcnt(4)
  ds_read_b64_tr_b16 a[56:57], v125 offset:0
  ds_read_b64_tr_b16 a[58:59], v125 offset:512
  ds_read_b64_tr_b16 a[60:61], v125 offset:8192
  ds_read_b64_tr_b16 a[62:63], v125 offset:8704
  ds_read_b64_tr_b16 a[120:121], v125 offset:8
  ds_read_b64_tr_b16 a[122:123], v125 offset:520
  ds_read_b64_tr_b16 a[124:125], v125 offset:8200
  ds_read_b64_tr_b16 a[126:127], v125 offset:8712
  s_waitcnt lgkmcnt(4)
  v_xor_b32 v122, 0x10000, v122
  v_xor_b32 v123, 0x10000, v123
  v_xor_b32 v124, 0x10000, v124
  v_xor_b32 v125, 0x10000, v125
  s_waitcnt lgkmcnt(0)
  s_barrier
  s_add_u32 s48, s45, 524288
  s_add_u32 m0, s44, 65536
  s_nop 0
  buffer_load_dwordx4 v120, s[16:19], s48 offen lds
  s_add_u32 s48, s45, 557056
  s_add_u32 m0, s44, 66560
  s_nop 0
  buffer_load_dwordx4 v120, s[16:19], s48 offen lds
  s_add_u32 s48, s45, 589824
  s_add_u32 m0, s44, 67584
  s_nop 0
  buffer_load_dwordx4 v120, s[16:19], s48 offen lds
  s_add_u32 s48, s45, 622592
  s_add_u32 m0, s44, 68608
  s_nop 0
  buffer_load_dwordx4 v120, s[16:19], s48 offen lds
  s_add_u32 s48, s45, 1572864
  s_add_u32 m0, s44, 81920
  s_nop 0
  buffer_load_dwordx4 v120, s[16:19], s48 offen lds
  s_add_u32 s48, s45, 1605632
  s_add_u32 m0, s44, 82944
  s_nop 0
  buffer_load_dwordx4 v120, s[16:19], s48 offen lds
  s_add_u32 s48, s45, 1638400
  s_add_u32 m0, s44, 83968
  s_nop 0
  buffer_load_dwordx4 v120, s[16:19], s48 offen lds
  s_add_u32 s48, s45, 1671168
  s_add_u32 m0, s44, 84992
  s_nop 0
  buffer_load_dwordx4 v120, s[16:19], s48 offen lds
  s_add_u32 s48, s45, 2621440
  s_add_u32 m0, s44, 98304
  s_nop 0
  buffer_load_dwordx4 v120, s[16:19], s48 offen lds
  s_add_u32 s48, s45, 2654208
  s_add_u32 m0, s44, 99328
  s_nop 0
  buffer_load_dwordx4 v120, s[16:19], s48 offen lds
  s_add_u32 s48, s45, 2686976
  s_add_u32 m0, s44, 100352
  s_nop 0
  buffer_load_dwordx4 v120, s[16:19], s48 offen lds
  s_add_u32 s48, s45, 2719744
  s_add_u32 m0, s44, 101376
  s_nop 0
  buffer_load_dwordx4 v120, s[16:19], s48 offen lds
  s_add_u32 s48, s45, 3670016
  s_add_u32 m0, s44, 114688
  s_nop 0
  buffer_load_dwordx4 v120, s[16:19], s48 offen lds
  s_add_u32 s48, s45, 3702784
  s_add_u32 m0, s44, 115712
  s_nop 0
  buffer_load_dwordx4 v120, s[16:19], s48 offen lds
  s_add_u32 s48, s45, 3735552
  s_add_u32 m0, s44, 116736
  s_nop 0
  buffer_load_dwordx4 v120, s[16:19], s48 offen lds
  s_add_u32 s48, s45, 3768320
  s_add_u32 m0, s44, 117760
  s_nop 0
  buffer_load_dwordx4 v120, s[16:19], s48 offen lds
  v_cmp_eq_u32 vcc, 0, v118
  s_cbranch_vccz CT_7
  s_mov_b32 s42, 0
  v_mov_b32 v119, 0
rdy_9:
  buffer_load_dword v118, v119, s[24:27], 0 offen offset:228 sc1
  s_waitcnt vmcnt(0)
  v_cmp_eq_u32 vcc, 0, v118
  s_cbranch_vccz rdyok_10
  s_sleep 1
  s_add_u32 s42, s42, 1
  s_cmp_lt_u32 s42, s6
  s_cbranch_scc1 rdy_9
  s_mov_b32 s6, 0
rdyok_10:
CT_7:
  v_readfirstlane_b32 s43, v118
  s_cmp_lg_u32 s43, s54
  s_cselect_b32 s100, 2, 1
  s_cbranch_scc0 CT2_8
  s_cmp_eq_u32 s101, 0
  s_cbranch_scc1 SWAP_2
CT2_8:
  v_and_b32 v105, 2, v1
  v_mul_u32_u24 v105, 0x10101, v105
  v_and_b32 v106, 2, v1
  v_lshl_add_u32 v105, v106, 24, v105
  v_add_u32 v105, 0x05040100, v105
  v_perm_b32 v32, v44, v40, v105
  v_perm_b32 v33, v45, v41, v105
  v_perm_b32 v34, v46, v42, v105
  v_perm_b32 v35, v47, v43, v105
  v_perm_b32 v36, v52, v48, v105
  v_perm_b32 v37, v53, v49, v105
  v_perm_b32 v38, v54, v50, v105
  v_perm_b32 v39, v55, v51, v105
  s_getpc_b64 s[60:61]
pc_11:
  s_add_u32 s60, s60, CW_5-pc_11
  s_addc_u32 s61, s61, 0
  s_lshl_b32 s43, s4, 13
  v_lshlrev_b32 v104, 7, v1
  v_min_u32 v105, CWe_6-CW_5-4, v104
  global_load_dword v116, v105, s[60:61]
  v_add_u32 v104, 0x2000, v104
  v_min_u32 v105, CWe_6-CW_5-4, v104
  global_load_dword v117, v105, s[60:61]
  s_waitcnt vmcnt(19)
  s_barrier
  ds_read_b64_tr_b16 a[128:129], v122 offset:0
  ds_read_b64_tr_b16 a[130:131], v122 offset:512
  ds_read_b64_tr_b16 a[132:133], v122 offset:8192
  ds_read_b64_tr_b16 a[134:135], v122 offset:8704
  ds_read_b64_tr_b16 a[192:193], v122 offset:8
  ds_read_b64_tr_b16 a[194:195], v122 offset:520
  ds_read_b64_tr_b16 a[196:197], v122 offset:8200
  ds_read_b64_tr_b16 a[198:199], v122 offset:8712
  s_waitcnt lgkmcnt(4)
  ds_read_b64_tr_b16 a[144:145], v123 offset:0
  ds_read_b64_tr_b16 a[146:147], v123 offset:512
  ds_read_b64_tr_b16 a[148:149], v123 offset:8192
  ds_read_b64_tr_b16 a[150:151], v123 offset:8704
  ds_read_b64_tr_b16 a[208:209], v123 offset:8
  ds_read_b64_tr_b16 a[210:211], v123 offset:520
  ds_read_b64_tr_b16 a[212:213], v123 offset:8200
  ds_read_b64_tr_b16 a[214:215], v123 offset:8712
  s_waitcnt lgkmcnt(4)
  ds_read_b64_tr_b16 a[160:161], v124 offset:0
  ds_read_b64_tr_b16 a[162:163], v124 offset:512
  ds_read_b64_tr_b16 a[164:165], v124 offset:8192
  ds_read_b64_tr_b16 a[166:167], v124 offset:8704
  ds_read_b64_tr_b16 a[224:225], v124 offset:8
  ds_read_b64_tr_b16 a[226:227], v124 offset:520
  ds_read_b64_tr_b16 a[228:229], v124 offset:8200
  ds_read_b64_tr_b16 a[230:231], v124 offset:8712
  s_waitcnt lgkmcnt(4)
  ds_read_b64_tr_b16 a[176:177], v125 offset:0
  ds_read_b64_tr_b16 a[178:179], v125 offset:512
  ds_read_b64_tr_b16 a[180:181], v125 offset:8192
  ds_read_b64_tr_b16 a[182:183], v125 offset:8704
  ds_read_b64_tr_b16 a[240:241], v125 offset:8
  ds_read_b64_tr_b16 a[242:243], v125 offset:520
  ds_read_b64_tr_b16 a[244:245], v125 offset:8200
  ds_read_b64_tr_b16 a[246:247], v125 offset:8712
  s_waitcnt lgkmcnt(4)
  v_xor_b32 v122, 0x10000, v122
  v_xor_b32 v123, 0x10000, v123
  v_xor_b32 v124, 0x10000, v124
  v_xor_b32 v125, 0x10000, v125
  s_waitcnt lgkmcnt(0)
  s_barrier
  s_add_u32 s48, s45, 524288
  s_add_u32 m0, s44, 0
  s_nop 0
  buffer_load_dwordx4 v120, s[20:23], s48 offen lds
  s_add_u32 s48, s45, 557056
  s_add_u32 m0, s44, 1024
  s_nop 0
  buffer_load_dwordx4 v120, s[20:23], s48 offen lds
  s_add_u32 s48, s45, 589824
  s_add_u32 m0, s44, 2048
  s_nop 0
  buffer_load_dwordx4 v120, s[20:23], s48 offen lds
  s_add_u32 s48, s45, 622592
  s_add_u32 m0, s44, 3072
  s_nop 0
  buffer_load_dwordx4 v120, s[20:23], s48 offen lds
  s_add_u32 s48, s45, 1572864
  s_add_u32 m0, s44, 16384
  s_nop 0
  buffer_load_dwordx4 v120, s[20:23], s48 offen lds
  s_add_u32 s48, s45, 1605632
  s_add_u32 m0, s44, 17408
  s_nop 0
  buffer_load_dwordx4 v120, s[20:23], s48 offen lds
  s_add_u32 s48, s45, 1638400
  s_add_u32 m0, s44, 18432
  s_nop 0
  buffer_load_dwordx4 v120, s[20:23], s48 offen lds
  s_add_u32 s48, s45, 1671168
  s_add_u32 m0, s44, 19456
  s_nop 0
  buffer_load_dwordx4 v120, s[20:23], s48 offen lds
  s_add_u32 s48, s45, 2621440
  s_add_u32 m0, s44, 32768
  s_nop 0
  buffer_load_dwordx4 v120, s[20:23], s48 offen lds
  s_add_u32 s48, s45, 2654208
  s_add_u32 m0, s44, 33792
  s_nop 0
  buffer_load_dwordx4 v120, s[20:23], s48 offen lds
  s_add_u32 s48, s45, 2686976
  s_add_u32 m0, s44, 34816
  s_nop 0
  buffer_load_dwordx4 v120, s[20:23], s48 offen lds
  s_add_u32 s48, s45, 2719744
  s_add_u32 m0, s44, 35840
  s_nop 0
  buffer_load_dwordx4 v120, s[20:23], s48 offen lds
  s_add_u32 s48, s45, 3670016
  s_add_u32 m0, s44, 49152
  s_nop 0
  buffer_load_dwordx4 v120, s[20:23], s48 offen lds
  s_add_u32 s48, s45, 3702784
  s_add_u32 m0, s44, 50176
  s_nop 0
  buffer_load_dwordx4 v120, s[20:23], s48 offen lds
  s_add_u32 s48, s45, 3735552
  s_add_u32 m0, s44, 51200
  s_nop 0
  buffer_load_dwordx4 v120, s[20:23], s48 offen lds
  s_add_u32 s48, s45, 3768320
  s_add_u32 m0, s44, 52224
  s_nop 0
  buffer_load_dwordx4 v120, s[20:23], s48 offen lds
  s_waitcnt vmcnt(18)
  s_barrier
  ds_read_b64_tr_b16 a[136:137], v122 offset:0
  ds_read_b64_tr_b16 a[138:139], v122 offset:512
  ds_read_b64_tr_b16 a[140:141], v122 offset:8192
  ds_read_b64_tr_b16 a[142:143], v122 offset:8704
  ds_read_b64_tr_b16 a[200:201], v122 offset:8
  ds_read_b64_tr_b16 a[202:203], v122 offset:520
  ds_read_b64_tr_b16 a[204:205], v122 offset:8200
  ds_read_b64_tr_b16 a[206:207], v122 offset:8712
  s_waitcnt lgkmcnt(4)
  ds_read_b64_tr_b16 a[152:153], v123 offset:0
  ds_read_b64_tr_b16 a[154:155], v123 offset:512
  ds_read_b64_tr_b16 a[156:157], v123 offset:8192
  ds_read_b64_tr_b16 a[158:159], v123 offset:8704
  ds_read_b64_tr_b16 a[216:217], v123 offset:8
  ds_read_b64_tr_b16 a[218:219], v123 offset:520
  ds_read_b64_tr_b16 a[220:221], v123 offset:8200
  ds_read_b64_tr_b16 a[222:223], v123 offset:8712
  s_waitcnt lgkmcnt(4)
  ds_read_b64_tr_b16 a[168:169], v124 offset:0
  ds_read_b64_tr_b16 a[170:171], v124 offset:512
  ds_read_b64_tr_b16 a[172:173], v124 offset:8192
  ds_read_b64_tr_b16 a[174:175], v124 offset:8704
  ds_read_b64_tr_b16 a[232:233], v124 offset:8
  ds_read_b64_tr_b16 a[234:235], v124 offset:520
  ds_read_b64_tr_b16 a[236:237], v124 offset:8200
  ds_read_b64_tr_b16 a[238:239], v124 offset:8712
  s_waitcnt lgkmcnt(4)
  ds_read_b64_tr_b16 a[184:185], v125 offset:0
  ds_read_b64_tr_b16 a[186:187], v125 offset:512
  ds_read_b64_tr_b16 a[188:189], v125 offset:8192
  ds_read_b64_tr_b16 a[190:191], v125 offset:8704
  ds_read_b64_tr_b16 a[248:249], v125 offset:8
  ds_read_b64_tr_b16 a[250:251], v125 offset:520
  ds_read_b64_tr_b16 a[252:253], v125 offset:8200
  ds_read_b64_tr_b16 a[254:255], v125 offset:8712
  s_waitcnt lgkmcnt(4)
  v_xor_b32 v122, 0x10000, v122
  v_xor_b32 v123, 0x10000, v123
  v_xor_b32 v124, 0x10000, v124
  v_xor_b32 v125, 0x10000, v125
  s_waitcnt lgkmcnt(0)
  s_barrier
  s_add_u32 s48, s49, 0
  s_add_u32 m0, s3, 0
  s_nop 0
  buffer_load_dwordx4 v121, s[28:31], s48 offen lds
  s_add_u32 s48, s49, 8192
  s_add_u32 m0, s3, 1024
  s_nop 0
  buffer_load_dwordx4 v121, s[28:31], s48 offen lds
  s_add_u32 s48, s49, 16384
  s_add_u32 m0, s3, 2048
  s_nop 0
  buffer_load_dwordx4 v121, s[28:31], s48 offen lds
  s_add_u32 s48, s49, 24576
  s_add_u32 m0, s3, 3072
  s_nop 0
  buffer_load_dwordx4 v121, s[28:31], s48 offen lds
  s_add_u32 s48, s49, 32768
  s_add_u32 m0, s3, 4096
  s_nop 0
  buffer_load_dwordx4 v121, s[28:31], s48 offen lds
  s_add_u32 s48, s49, 40960
  s_add_u32 m0, s3, 5120
  s_nop 0
  buffer_load_dwordx4 v121, s[28:31], s48 offen lds
  s_add_u32 s48, s49, 49152
  s_add_u32 m0, s3, 6144
  s_nop 0
  buffer_load_dwordx4 v121, s[28:31], s48 offen lds
  s_add_u32 s48, s49, 57344
  s_add_u32 m0, s3, 7168
  s_nop 0
  buffer_load_dwordx4 v121, s[28:31], s48 offen lds
  s_add_u32 s48, s49, 65536
  s_add_u32 m0, s3, 8192
  s_nop 0
  buffer_load_dwordx4 v121, s[28:31], s48 offen lds
  s_add_u32 s48, s49, 73728
  s_add_u32 m0, s3, 9216
  s_nop 0
  buffer_load_dwordx4 v121, s[28:31], s48 offen lds
  s_add_u32 s48, s49, 81920
  s_add_u32 m0, s3, 10240
  s_nop 0
  buffer_load_dwordx4 v121, s[28:31], s48 offen lds
  s_add_u32 s48, s49, 90112
  s_add_u32 m0, s3, 11264
  s_nop 0
  buffer_load_dwordx4 v121, s[28:31], s48 offen lds
  s_add_u32 s48, s49, 98304
  s_add_u32 m0, s3, 12288
  s_nop 0
  buffer_load_dwordx4 v121, s[28:31], s48 offen lds
  s_add_u32 s48, s49, 106496
  s_add_u32 m0, s3, 13312
  s_nop 0
  buffer_load_dwordx4 v121, s[28:31], s48 offen lds
  s_add_u32 s48, s49, 114688
  s_add_u32 m0, s3, 14336
  s_nop 0
  buffer_load_dwordx4 v121, s[28:31], s48 offen lds
  s_add_u32 s48, s49, 122880
  s_add_u32 m0, s3, 15360
  s_nop 0
  buffer_load_dwordx4 v121, s[28:31], s48 offen lds
  v_mov_b32 v106, s100
  s_lshl_b32 s43, s4, 30
  s_lshr_b32 s42, s43, 1
  s_or_b32 s43, s43, s42
  s_and_b32 s43, s43, 0x40000000
  v_mov_b32 v105, 0x40000000
  v_cmp_eq_u32 vcc, 0, v108
  v_mov_b32 v104, s43
  s_nop 0
  v_cndmask_b32 v105, v104, v105, vcc
  buffer_store_dword v106, v105, s[8:11], s47 offen offset:0 sc1
  s_waitcnt vmcnt(17)
  s_barrier
  ds_read_b64_tr_b16 v[128:129], v122 offset:0
  ds_read_b64_tr_b16 v[130:131], v122 offset:512
  ds_read_b64_tr_b16 v[132:133], v122 offset:8192
  ds_read_b64_tr_b16 v[134:135], v122 offset:8704
  ds_read_b64_tr_b16 v[136:137], v122 offset:8
  ds_read_b64_tr_b16 v[138:139], v122 offset:520
  ds_read_b64_tr_b16 v[140:141], v122 offset:8200
  ds_read_b64_tr_b16 v[142:143], v122 offset:8712
  s_waitcnt lgkmcnt(4)
  ds_read_b64_tr_b16 v[144:145], v123 offset:0
  ds_read_b64_tr_b16 v[146:147], v123 offset:512
  ds_read_b64_tr_b16 v[148:149], v123 offset:8192
  ds_read_b64_tr_b16 v[150:151], v123 offset:8704
  ds_read_b64_tr_b16 v[152:153], v123 offset:8
  ds_read_b64_tr_b16 v[154:155], v123 offset:520
  ds_read_b64_tr_b16 v[156:157], v123 offset:8200
  ds_read_b64_tr_b16 v[158:159], v123 offset:8712
  s_waitcnt lgkmcnt(4)
  ds_read_b64_tr_b16 v[160:161], v124 offset:0
  ds_read_b64_tr_b16 v[162:163], v124 offset:512
  ds_read_b64_tr_b16 v[164:165], v124 offset:8192
  ds_read_b64_tr_b16 v[166:167], v124 offset:8704
  ds_read_b64_tr_b16 v[168:169], v124 offset:8
  ds_read_b64_tr_b16 v[170:171], v124 offset:520
  ds_read_b64_tr_b16 v[172:173], v124 offset:8200
  ds_read_b64_tr_b16 v[174:175], v124 offset:8712
  s_waitcnt lgkmcnt(4)
  ds_read_b64_tr_b16 v[176:177], v125 offset:0
  ds_read_b64_tr_b16 v[178:179], v125 offset:512
  ds_read_b64_tr_b16 v[180:181], v125 offset:8192
  ds_read_b64_tr_b16 v[182:183], v125 offset:8704
  ds_read_b64_tr_b16 v[184:185], v125 offset:8
  ds_read_b64_tr_b16 v[186:187], v125 offset:520
  ds_read_b64_tr_b16 v[188:189], v125 offset:8200
  ds_read_b64_tr_b16 v[190:191], v125 offset:8712
  s_waitcnt lgkmcnt(4)
  s_waitcnt lgkmcnt(0)
  s_barrier
  v_mov_b32 v106, s100
  s_lshl_b32 s43, s4, 30
  s_lshr_b32 s42, s43, 1
  s_or_b32 s43, s43, s42
  s_and_b32 s43, s43, 0x40000000
  v_mov_b32 v105, 0x40000000
  v_cmp_eq_u32 vcc, 0, v108
  v_mov_b32 v104, s43
  s_nop 0
  v_cndmask_b32 v105, v104, v105, vcc
  buffer_store_dword v106, v105, s[8:11], s47 offen offset:64 sc1
  s_add_u32 s48, s45, 0
  s_add_u32 m0, s44, 0
  s_nop 0
  buffer_load_dwordx4 v120, s[20:23], s48 offen lds
  s_add_u32 s48, s45, 32768
  s_add_u32 m0, s44, 1024
  s_nop 0
  buffer_load_dwordx4 v120, s[20:23], s48 offen lds
  s_add_u32 s48, s45, 65536
  s_add_u32 m0, s44, 2048
  s_nop 0
  buffer_load_dwordx4 v120, s[20:23], s48 offen lds
  s_add_u32 s48, s45, 98304
  s_add_u32 m0, s44, 3072
  s_nop 0
  buffer_load_dwordx4 v120, s[20:23], s48 offen lds
  s_add_u32 s48, s45, 1048576
  s_add_u32 m0, s44, 16384
  s_nop 0
  buffer_load_dwordx4 v120, s[20:23], s48 offen lds
  s_add_u32 s48, s45, 1081344
  s_add_u32 m0, s44, 17408
  s_nop 0
  buffer_load_dwordx4 v120, s[20:23], s48 offen lds
  s_add_u32 s48, s45, 1114112
  s_add_u32 m0, s44, 18432
  s_nop 0
  buffer_load_dwordx4 v120, s[20:23], s48 offen lds
  s_add_u32 s48, s45, 1146880
  s_add_u32 m0, s44, 19456
  s_nop 0
  buffer_load_dwordx4 v120, s[20:23], s48 offen lds
  s_add_u32 s48, s45, 2097152
  s_add_u32 m0, s44, 32768
  s_nop 0
  buffer_load_dwordx4 v120, s[20:23], s48 offen lds
  s_add_u32 s48, s45, 2129920
  s_add_u32 m0, s44, 33792
  s_nop 0
  buffer_load_dwordx4 v120, s[20:23], s48 offen lds
  s_add_u32 s48, s45, 2162688
  s_add_u32 m0, s44, 34816
  s_nop 0
  buffer_load_dwordx4 v120, s[20:23], s48 offen lds
  s_add_u32 s48, s45, 2195456
  s_add_u32 m0, s44, 35840
  s_nop 0
  buffer_load_dwordx4 v120, s[20:23], s48 offen lds
  s_add_u32 s48, s45, 3145728
  s_add_u32 m0, s44, 49152
  s_nop 0
  buffer_load_dwordx4 v120, s[20:23], s48 offen lds
  s_add_u32 s48, s45, 3178496
  s_add_u32 m0, s44, 50176
  s_nop 0
  buffer_load_dwordx4 v120, s[20:23], s48 offen lds
  s_add_u32 s48, s45, 3211264
  s_add_u32 m0, s44, 51200
  s_nop 0
  buffer_load_dwordx4 v120, s[20:23], s48 offen lds
  s_add_u32 s48, s45, 3244032
  s_add_u32 m0, s44, 52224
  s_nop 0
  buffer_load_dwordx4 v120, s[20:23], s48 offen lds
  buffer_load_dword v109, v0, s[8:11], s46 offen sc1
  s_xor_b32 s43, s34, 0x0
  buffer_load_dwordx4 v[112:115], v11, s[8:11], s43 offen offset:0 sc1
  buffer_load_dwordx4 v[112:115], v11, s[8:11], s43 offen offset:1024 sc1
  s_xor_b32 s43, s34, 0x40000
  buffer_load_dwordx4 v[112:115], v11, s[8:11], s43 offen offset:0 sc1
  buffer_load_dwordx4 v[112:115], v11, s[8:11], s43 offen offset:1024 sc1
  s_xor_b32 s43, s36, 0x0
  buffer_load_dwordx4 v[112:115], v11, s[8:11], s43 offen offset:0 sc1
  buffer_load_dwordx4 v[112:115], v11, s[8:11], s43 offen offset:1024 sc1
  s_xor_b32 s43, s36, 0x2000
  buffer_load_dwordx4 v[112:115], v11, s[8:11], s43 offen offset:0 sc1
  buffer_load_dwordx4 v[112:115], v11, s[8:11], s43 offen offset:1024 sc1
  s_waitcnt vmcnt(27)
  s_barrier
  ds_read_b64_tr_b16 v[192:193], v126 offset:0
  ds_read_b64_tr_b16 v[194:195], v126 offset:256
  ds_read_b64_tr_b16 v[196:197], v126 offset:2048
  ds_read_b64_tr_b16 v[198:199], v126 offset:2304
  ds_read_b64_tr_b16 v[200:201], v126 offset:8192
  ds_read_b64_tr_b16 v[202:203], v126 offset:8448
  ds_read_b64_tr_b16 v[204:205], v126 offset:10240
  ds_read_b64_tr_b16 v[206:207], v126 offset:10496
  s_waitcnt lgkmcnt(4)
  ds_read_b64_tr_b16 v[208:209], v126 offset:32
  ds_read_b64_tr_b16 v[210:211], v126 offset:288
  ds_read_b64_tr_b16 v[212:213], v126 offset:2080
  ds_read_b64_tr_b16 v[214:215], v126 offset:2336
  ds_read_b64_tr_b16 v[216:217], v126 offset:8224
  ds_read_b64_tr_b16 v[218:219], v126 offset:8480
  ds_read_b64_tr_b16 v[220:221], v126 offset:10272
  ds_read_b64_tr_b16 v[222:223], v126 offset:10528
  s_waitcnt lgkmcnt(4)
  ds_read_b64_tr_b16 v[224:225], v126 offset:64
  ds_read_b64_tr_b16 v[226:227], v126 offset:320
  ds_read_b64_tr_b16 v[228:229], v126 offset:2112
  ds_read_b64_tr_b16 v[230:231], v126 offset:2368
  ds_read_b64_tr_b16 v[232:233], v126 offset:8256
  ds_read_b64_tr_b16 v[234:235], v126 offset:8512
  ds_read_b64_tr_b16 v[236:237], v126 offset:10304
  ds_read_b64_tr_b16 v[238:239], v126 offset:10560
  s_waitcnt lgkmcnt(4)
  ds_read_b64_tr_b16 v[240:241], v126 offset:96
  ds_read_b64_tr_b16 v[242:243], v126 offset:352
  ds_read_b64_tr_b16 v[244:245], v126 offset:2144
  ds_read_b64_tr_b16 v[246:247], v126 offset:2400
  ds_read_b64_tr_b16 v[248:249], v126 offset:8288
  ds_read_b64_tr_b16 v[250:251], v126 offset:8544
  ds_read_b64_tr_b16 v[252:253], v126 offset:10336
  ds_read_b64_tr_b16 v[254:255], v126 offset:10592
  s_waitcnt lgkmcnt(4)
  s_waitcnt lgkmcnt(0)
  s_barrier
  s_add_u32 s48, s49, 128
  s_add_u32 m0, s3, 0
  s_nop 0
  buffer_load_dwordx4 v121, s[28:31], s48 offen lds
  s_add_u32 s48, s49, 8320
  s_add_u32 m0, s3, 1024
  s_nop 0
  buffer_load_dwordx4 v121, s[28:31], s48 offen lds
  s_add_u32 s48, s49, 16512
  s_add_u32 m0, s3, 2048
  s_nop 0
  buffer_load_dwordx4 v121, s[28:31], s48 offen lds
  s_add_u32 s48, s49, 24704
  s_add_u32 m0, s3, 3072
  s_nop 0
  buffer_load_dwordx4 v121, s[28:31], s48 offen lds
  s_add_u32 s48, s49, 32896
  s_add_u32 m0, s3, 4096
  s_nop 0
  buffer_load_dwordx4 v121, s[28:31], s48 offen lds
  s_add_u32 s48, s49, 41088
  s_add_u32 m0, s3, 5120
  s_nop 0
  buffer_load_dwordx4 v121, s[28:31], s48 offen lds
  s_add_u32 s48, s49, 49280
  s_add_u32 m0, s3, 6144
  s_nop 0
  buffer_load_dwordx4 v121, s[28:31], s48 offen lds
  s_add_u32 s48, s49, 57472
  s_add_u32 m0, s3, 7168
  s_nop 0
  buffer_load_dwordx4 v121, s[28:31], s48 offen lds
  s_add_u32 s48, s49, 65664
  s_add_u32 m0, s3, 8192
  s_nop 0
  buffer_load_dwordx4 v121, s[28:31], s48 offen lds
  s_add_u32 s48, s49, 73856
  s_add_u32 m0, s3, 9216
  s_nop 0
  buffer_load_dwordx4 v121, s[28:31], s48 offen lds
  s_add_u32 s48, s49, 82048
  s_add_u32 m0, s3, 10240
  s_nop 0
  buffer_load_dwordx4 v121, s[28:31], s48 offen lds
  s_add_u32 s48, s49, 90240
  s_add_u32 m0, s3, 11264
  s_nop 0
  buffer_load_dwordx4 v121, s[28:31], s48 offen lds
  s_add_u32 s48, s49, 98432
  s_add_u32 m0, s3, 12288
  s_nop 0
  buffer_load_dwordx4 v121, s[28:31], s48 offen lds
  s_add_u32 s48, s49, 106624
  s_add_u32 m0, s3, 13312
  s_nop 0
  buffer_load_dwordx4 v121, s[28:31], s48 offen lds
  s_add_u32 s48, s49, 114816
  s_add_u32 m0, s3, 14336
  s_nop 0
  buffer_load_dwordx4 v121, s[28:31], s48 offen lds
  s_add_u32 s48, s49, 123008
  s_add_u32 m0, s3, 15360
  s_nop 0
  buffer_load_dwordx4 v121, s[28:31], s48 offen lds
  s_waitcnt vmcnt(25)
  s_barrier
  ds_read_b64_tr_b16 v[40:41], v122 offset:0
  ds_read_b64_tr_b16 v[42:43], v122 offset:512
  ds_read_b64_tr_b16 v[44:45], v122 offset:8192
  ds_read_b64_tr_b16 v[46:47], v122 offset:8704
  ds_read_b64_tr_b16 v[48:49], v122 offset:8
  ds_read_b64_tr_b16 v[50:51], v122 offset:520
  ds_read_b64_tr_b16 v[52:53], v122 offset:8200
  ds_read_b64_tr_b16 v[54:55], v122 offset:8712
  s_waitcnt lgkmcnt(4)
  ds_read_b64_tr_b16 v[56:57], v123 offset:0
  ds_read_b64_tr_b16 v[58:59], v123 offset:512
  ds_read_b64_tr_b16 v[60:61], v123 offset:8192
  ds_read_b64_tr_b16 v[62:63], v123 offset:8704
  ds_read_b64_tr_b16 v[64:65], v123 offset:8
  ds_read_b64_tr_b16 v[66:67], v123 offset:520
  ds_read_b64_tr_b16 v[68:69], v123 offset:8200
  ds_read_b64_tr_b16 v[70:71], v123 offset:8712
  s_waitcnt lgkmcnt(4)
  ds_read_b64_tr_b16 v[72:73], v124 offset:0
  ds_read_b64_tr_b16 v[74:75], v124 offset:512
  ds_read_b64_tr_b16 v[76:77], v124 offset:8192
  ds_read_b64_tr_b16 v[78:79], v124 offset:8704
  ds_read_b64_tr_b16 v[80:81], v124 offset:8
  ds_read_b64_tr_b16 v[82:83], v124 offset:520
  ds_read_b64_tr_b16 v[84:85], v124 offset:8200
  ds_read_b64_tr_b16 v[86:87], v124 offset:8712
  s_waitcnt lgkmcnt(4)
  ds_read_b64_tr_b16 v[88:89], v125 offset:0
  ds_read_b64_tr_b16 v[90:91], v125 offset:512
  ds_read_b64_tr_b16 v[92:93], v125 offset:8192
  ds_read_b64_tr_b16 v[94:95], v125 offset:8704
  ds_read_b64_tr_b16 v[96:97], v125 offset:8
  ds_read_b64_tr_b16 v[98:99], v125 offset:520
  ds_read_b64_tr_b16 v[100:101], v125 offset:8200
  ds_read_b64_tr_b16 v[102:103], v125 offset:8712
  s_waitcnt lgkmcnt(4)
  s_waitcnt lgkmcnt(0)
  s_barrier
  ds_write_b128 v9, v[40:43] offset:0
  ds_write_b128 v9, v[44:47] offset:1024
  ds_write_b128 v9, v[48:51] offset:2048
  ds_write_b128 v9, v[52:55] offset:3072
  ds_write_b128 v9, v[56:59] offset:4096
  ds_write_b128 v9, v[60:63] offset:5120
  ds_write_b128 v9, v[64:67] offset:6144
  ds_write_b128 v9, v[68:71] offset:7168
  s_waitcnt lgkmcnt(0)
  ds_write_b128 v9, v[72:75] offset:8192
  ds_write_b128 v9, v[76:79] offset:9216
  ds_write_b128 v9, v[80:83] offset:10240
  ds_write_b128 v9, v[84:87] offset:11264
  ds_write_b128 v9, v[88:91] offset:12288
  ds_write_b128 v9, v[92:95] offset:13312
  ds_write_b128 v9, v[96:99] offset:14336
  ds_write_b128 v9, v[100:103] offset:15360
  s_waitcnt lgkmcnt(0)
  s_waitcnt vmcnt(16)
  v_cmp_eq_u32 vcc, 0, v108
  s_or_b32 s55, vcc_lo, vcc_hi
  v_cmp_ge_u32 vcc, 1, v109
  s_or_b32 s55, s55, vcc_lo
  s_mov_b32 m0, s38
  s_nop 0
  buffer_load_dwordx4 v11, s[8:11], s37 offen sc1 lds
  buffer_load_dwordx4 v11, s[8:11], s37 offen offset:1024 sc1 lds
  buffer_load_dwordx4 v[24:27], v11, s[8:11], s40 offen sc1
  buffer_load_dwordx4 v[28:31], v11, s[8:11], s40 offen offset:1024 sc1
  v_and_b32 v111, 31, v1
  v_lshlrev_b32 v111, 7, v111
  s_mov_b32 s63, 0x7202000
  buffer_load_dword v110, v111, s[8:11], s63 offen sc1
  s_waitcnt vmcnt(5)
  s_barrier
  ds_read_b64_tr_b16 v[40:41], v126 offset:0
  ds_read_b64_tr_b16 v[42:43], v126 offset:256
  ds_read_b64_tr_b16 v[44:45], v126 offset:2048
  ds_read_b64_tr_b16 v[46:47], v126 offset:2304
  ds_read_b64_tr_b16 v[48:49], v126 offset:8192
  ds_read_b64_tr_b16 v[50:51], v126 offset:8448
  ds_read_b64_tr_b16 v[52:53], v126 offset:10240
  ds_read_b64_tr_b16 v[54:55], v126 offset:10496
  s_waitcnt lgkmcnt(4)
  ds_read_b64_tr_b16 v[56:57], v126 offset:32
  ds_read_b64_tr_b16 v[58:59], v126 offset:288
  ds_read_b64_tr_b16 v[60:61], v126 offset:2080
  ds_read_b64_tr_b16 v[62:63], v126 offset:2336
  ds_read_b64_tr_b16 v[64:65], v126 offset:8224
  ds_read_b64_tr_b16 v[66:67], v126 offset:8480
  ds_read_b64_tr_b16 v[68:69], v126 offset:10272
  ds_read_b64_tr_b16 v[70:71], v126 offset:10528
  s_waitcnt lgkmcnt(4)
  ds_read_b64_tr_b16 v[72:73], v126 offset:64
  ds_read_b64_tr_b16 v[74:75], v126 offset:320
  ds_read_b64_tr_b16 v[76:77], v126 offset:2112
  ds_read_b64_tr_b16 v[78:79], v126 offset:2368
  ds_read_b64_tr_b16 v[80:81], v126 offset:8256
  ds_read_b64_tr_b16 v[82:83], v126 offset:8512
  ds_read_b64_tr_b16 v[84:85], v126 offset:10304
  ds_read_b64_tr_b16 v[86:87], v126 offset:10560
  s_waitcnt lgkmcnt(4)
  ds_read_b64_tr_b16 v[88:89], v126 offset:96
  ds_read_b64_tr_b16 v[90:91], v126 offset:352
  ds_read_b64_tr_b16 v[92:93], v126 offset:2144
  ds_read_b64_tr_b16 v[94:95], v126 offset:2400
  ds_read_b64_tr_b16 v[96:97], v126 offset:8288
  ds_read_b64_tr_b16 v[98:99], v126 offset:8544
  ds_read_b64_tr_b16 v[100:101], v126 offset:10336
  ds_read_b64_tr_b16 v[102:103], v126 offset:10592
  s_waitcnt lgkmcnt(4)
  s_waitcnt lgkmcnt(0)
  s_barrier
  ds_write_b128 v13, v[40:43] offset:0
  ds_write_b128 v13, v[44:47] offset:1024
  ds_write_b128 v13, v[48:51] offset:2048
  ds_write_b128 v13, v[52:55] offset:3072
  ds_write_b128 v13, v[56:59] offset:4096
  ds_write_b128 v13, v[60:63] offset:5120
  ds_write_b128 v13, v[64:67] offset:6144
  ds_write_b128 v13, v[68:71] offset:7168
  s_waitcnt lgkmcnt(0)
  ds_write_b128 v13, v[72:75] offset:8192
  ds_write_b128 v13, v[76:79] offset:9216
  ds_write_b128 v13, v[80:83] offset:10240
  ds_write_b128 v13, v[84:87] offset:11264
  ds_write_b128 v13, v[88:91] offset:12288
  ds_write_b128 v13, v[92:95] offset:13312
  ds_write_b128 v13, v[96:99] offset:14336
  ds_write_b128 v13, v[100:103] offset:15360
  s_waitcnt lgkmcnt(0)
  s_cmp_eq_u32 s55, 0
  s_cbranch_scc1 CHf_12
  s_mov_b32 s42, 0
  v_mov_b32 v109, 0
rdy_13:
  buffer_load_dword v108, v109, s[24:27], 0 offen offset:224 sc1
  s_waitcnt vmcnt(0)
  v_cmp_eq_u32 vcc, 0, v108
  s_cbranch_vccz rdyok_14
  s_sleep 1
  s_add_u32 s42, s42, 1
  s_cmp_lt_u32 s42, s6
  s_cbranch_scc1 rdy_13
  s_mov_b32 s6, 0
rdyok_14:
  v_mov_b32 v106, s100
  s_lshl_b32 s43, s4, 30
  s_lshr_b32 s42, s43, 1
  s_or_b32 s43, s43, s42
  s_and_b32 s43, s43, 0x40000000
  v_mov_b32 v105, 0x40000000
  v_cmp_eq_u32 vcc, 0, v108
  v_mov_b32 v104, s43
  s_nop 0
  v_cndmask_b32 v105, v104, v105, vcc
  buffer_store_dword v106, v105, s[8:11], s47 offen offset:0 sc1
  v_mov_b32 v106, s100
  s_lshl_b32 s43, s4, 30
  s_lshr_b32 s42, s43, 1
  s_or_b32 s43, s43, s42
  s_and_b32 s43, s43, 0x40000000
  v_mov_b32 v105, 0x40000000
  v_cmp_eq_u32 vcc, 0, v108
  v_mov_b32 v104, s43
  s_nop 0
  v_cndmask_b32 v105, v104, v105, vcc
  buffer_store_dword v106, v105, s[8:11], s47 offen offset:64 sc1
  v_mov_b32 v110, 0
  s_mov_b32 s42, 0
  s_add_u32 s43, s7, 1
kvr_15:
  buffer_load_dword v1, v0, s[8:11], s46 offen sc1
  s_waitcnt vmcnt(0)
  v_cmp_ge_u32 vcc, s43, v1
  s_cbranch_vccz kvok_16
  s_sleep 2
  s_add_u32 s42, s42, 1
  s_cmp_lt_u32 s42, s6
  s_cbranch_scc1 kvr_15
  s_mov_b32 s6, 0
kvok_16:
  s_mov_b32 m0, s38
  s_nop 0
  buffer_load_dwordx4 v11, s[8:11], s37 offen sc1 lds
  buffer_load_dwordx4 v11, s[8:11], s37 offen offset:1024 sc1 lds
  buffer_load_dwordx4 v[24:27], v11, s[8:11], s40 offen sc1
  buffer_load_dwordx4 v[28:31], v11, s[8:11], s40 offen offset:1024 sc1
CHf_12:
  s_mov_b32 s55, 1
  s_mov_b32 s49, 0x42700000
  s_add_u32 s37, s37, 0x40000
  s_add_u32 s40, s40, 0x40000
  s_xor_b32 s38, s38, 0x2000
  s_waitcnt vmcnt(0)
  v_mov_b32 v16, v110
  v_mov_b32 v17, v111
  ds_read_b128 v[88:91], v9 offset:0
  ds_read_b128 v[92:95], v9 offset:1024
  ds_read_b128 v[96:99], v9 offset:2048
  ds_read_b128 v[100:103], v9 offset:3072
  ds_read_b128 v[104:107], v9 offset:4096
  ds_read_b128 v[108:111], v9 offset:5120
  ds_read_b128 v[112:115], v9 offset:6144
  ds_read_b128 v[116:119], v9 offset:7168
  v_mov_b32 v64, 0
  v_mov_b32 v65, 0
  v_mov_b32 v66, 0
  v_mov_b32 v67, 0
  v_mov_b32 v68, 0
  v_mov_b32 v69, 0
  v_mov_b32 v70, 0
  v_mov_b32 v71, 0
  v_mov_b32 v72, 0
  v_mov_b32 v73, 0
  v_mov_b32 v74, 0
  v_mov_b32 v75, 0
  v_mov_b32 v76, 0
  v_mov_b32 v77, 0
  v_mov_b32 v78, 0
  v_mov_b32 v79, 0
  v_mov_b32 v80, 0
  v_mov_b32 v81, 0
  v_mov_b32 v82, 0
  v_mov_b32 v83, 0
  v_mov_b32 v84, 0
  v_mov_b32 v85, 0
  v_mov_b32 v86, 0
  v_mov_b32 v87, 0
  s_mov_b32 s42, 0
CHs_17:
  v_cmp_eq_u32 vcc, 0, v16
  s_cbranch_vccz CHok_18
  s_sleep 2
  buffer_load_dword v16, v17, s[8:11], s63 offen sc1
  s_waitcnt vmcnt(0)
  s_add_u32 s42, s42, 1
  s_cmp_lt_u32 s42, s6
  s_cbranch_scc1 CHs_17
  s_mov_b32 s6, 0
CHok_18:
  v_cmp_ne_u32 vcc, 1, v16
  s_or_b32 s44, vcc_lo, vcc_hi
  v_mov_b32 v120, v24
  v_mov_b32 v121, v25
  v_mov_b32 v122, v26
  v_mov_b32 v123, v27
  v_mov_b32 v124, v28
  v_mov_b32 v125, v29
  v_mov_b32 v126, v30
  v_mov_b32 v127, v31
  s_waitcnt lgkmcnt(0)
  s_mov_b32 m0, s38
  v_mov_b32 v1, 0
  s_lshr_b32 s34, s5, 1
  s_lshl_b32 s34, s34, 14
  s_and_b32 s43, s4, 1
  s_lshl_b32 s43, s43, 13
  s_add_u32 s34, s34, s43
  s_and_b32 s43, s5, 1
  s_lshl_b32 s43, s43, 12
  s_add_u32 s34, s34, s43
  s_add_u32 s34, s34, 0x7000000
  s_add_u32 s56, s32, 0x2000
  s_add_u32 s57, s32, 0x3000
  s_cmp_lg_u32 s44, 0
  s_cbranch_scc1 CHslow_19
CW_5:
  ds_write_b128 v2, v[32:35]
  s_branch Fs0v_32
.p2align 6
  s_nop 0
Fs0f_29:
  v_max_u32 v52, v35, v39
  v_cmp_eq_u32 vcc, -1, v52
  s_cbranch_vccz Fs0v_32
  buffer_load_dwordx4 v[32:35], v11, s[8:11], s36 offen sc1
  buffer_load_dwordx4 v[36:39], v11, s[8:11], s36 offen offset:1024 sc1
  s_add_u32 s42, s42, 1
  s_cmp_ge_u32 s42, s6
  s_cbranch_scc1 Fto_31
  s_waitcnt vmcnt(3)
  ds_write_b128 v2, v[24:27]
Far2_36:
  s_waitcnt vmcnt(2)
  v_cmp_u_f32 vcc, v27, v31
  s_cbranch_vccnz Fs0f_30
Fs0v_33:
  v_smfmac_f32_16x16x64_bf16 v[64:67], v[24:27], a[0:7], v15
  v_smfmac_f32_16x16x64_bf16 v[68:71], v[24:27], a[64:71], v15
  v_smfmac_f32_16x16x64_bf16 v[72:75], v[24:27], a[128:135], v15
  ds_write_b128 v2, v[28:31] offset:1024
  v_smfmac_f32_16x16x64_bf16 v[76:79], v[24:27], a[192:199], v15
  v_smfmac_f32_16x16x64_bf16 v[64:67], v[28:31], a[8:15], v15
  v_smfmac_f32_16x16x64_bf16 v[68:71], v[28:31], a[72:79], v15
  v_smfmac_f32_16x16x64_bf16 v[72:75], v[28:31], a[136:143], v15
  s_waitcnt lgkmcnt(0)
  s_barrier
  ds_read_b128 v[40:43], v3 offset:0
  v_smfmac_f32_16x16x64_bf16 v[76:79], v[28:31], a[200:207], v15
  ds_read_b128 v[44:47], v3 offset:1024
  v_smfmac_f32_16x16x64_bf16 v[80:83], v[24:27], v[88:95], v15
  ds_read_b128 v[48:51], v4 offset:0
  v_smfmac_f32_16x16x64_bf16 v[84:87], v[24:27], v[96:103], v15
  ds_read_b128 v[52:55], v4 offset:1024
  v_smfmac_f32_16x16x64_bf16 v[80:83], v[28:31], v[128:135], v15
  ds_read_b128 v[56:59], v5 offset:0
  v_smfmac_f32_16x16x64_bf16 v[84:87], v[28:31], v[136:143], v15
  ds_read_b128 v[60:63], v5 offset:1024
  s_branch Fcom_34
.p2align 6
  s_nop 0
Fs0f_30:
  v_max_u32 v52, v27, v31
  v_cmp_eq_u32 vcc, -1, v52
  s_cbranch_vccz Fs0v_33
  buffer_load_dwordx4 v[24:27], v11, s[8:11], s36 offen sc1
  buffer_load_dwordx4 v[28:31], v11, s[8:11], s36 offen offset:1024 sc1
  s_add_u32 s42, s42, 1
  s_cmp_ge_u32 s42, s6
  s_cbranch_scc1 Fto_31
Fpoll_35:
  s_waitcnt vmcnt(3)
  ds_write_b128 v2, v[32:35]
Far2_37:
  s_waitcnt vmcnt(2)
  v_cmp_u_f32 vcc, v35, v39
  s_cbranch_vccnz Fs0f_29
Fs0v_32:
  v_smfmac_f32_16x16x64_bf16 v[64:67], v[32:35], a[0:7], v15
  v_smfmac_f32_16x16x64_bf16 v[68:71], v[32:35], a[64:71], v15
  v_smfmac_f32_16x16x64_bf16 v[72:75], v[32:35], a[128:135], v15
  ds_write_b128 v2, v[36:39] offset:1024
  v_smfmac_f32_16x16x64_bf16 v[76:79], v[32:35], a[192:199], v15
  v_smfmac_f32_16x16x64_bf16 v[64:67], v[36:39], a[8:15], v15
  v_smfmac_f32_16x16x64_bf16 v[68:71], v[36:39], a[72:79], v15
  v_smfmac_f32_16x16x64_bf16 v[72:75], v[36:39], a[136:143], v15
  s_waitcnt lgkmcnt(0)
  s_barrier
  ds_read_b128 v[40:43], v3 offset:0
  v_smfmac_f32_16x16x64_bf16 v[76:79], v[36:39], a[200:207], v15
  ds_read_b128 v[44:47], v3 offset:1024
  v_smfmac_f32_16x16x64_bf16 v[80:83], v[32:35], v[88:95], v15
  ds_read_b128 v[48:51], v4 offset:0
  v_smfmac_f32_16x16x64_bf16 v[84:87], v[32:35], v[96:103], v15
  ds_read_b128 v[52:55], v4 offset:1024
  v_smfmac_f32_16x16x64_bf16 v[80:83], v[36:39], v[128:135], v15
  ds_read_b128 v[56:59], v5 offset:0
  v_smfmac_f32_16x16x64_bf16 v[84:87], v[36:39], v[136:143], v15
  ds_read_b128 v[60:63], v5 offset:1024
Fcom_34:
  s_waitcnt lgkmcnt(4)
  v_smfmac_f32_16x16x64_bf16 v[64:67], v[40:43], a[16:23], v15
  s_waitcnt vmcnt(0)
  buffer_store_dwordx4 v[16:19], v11, s[8:11], s39 offen sc1
  v_smfmac_f32_16x16x64_bf16 v[68:71], v[40:43], a[80:87], v15
  s_cmp_lg_u32 s55, 0
  s_cbranch_scc1 Frqf_38
Fbqf_39:
  v_smfmac_f32_16x16x64_bf16 v[64:67], v[44:47], a[24:31], v15
  ds_read_b128 v[88:91], v9 offset:8192
  v_smfmac_f32_16x16x64_bf16 v[68:71], v[44:47], a[88:95], v15
  buffer_load_dwordx4 v[24:27], v11, s[8:11], s40 offen sc1
  s_waitcnt lgkmcnt(1)
  v_smfmac_f32_16x16x64_bf16 v[64:67], v[48:51], a[32:39], v15
  ds_read_b128 v[92:95], v9 offset:9216
  v_smfmac_f32_16x16x64_bf16 v[68:71], v[48:51], a[96:103], v15
  buffer_load_dwordx4 v[28:31], v11, s[8:11], s40 offen offset:1024 sc1
  v_smfmac_f32_16x16x64_bf16 v[64:67], v[52:55], a[40:47], v15
  ds_read_b128 v[96:99], v9 offset:10240
  v_smfmac_f32_16x16x64_bf16 v[68:71], v[52:55], a[104:111], v15
  buffer_load_dwordx4 v11, s[8:11], s37 offen sc1 lds
  v_smfmac_f32_16x16x64_bf16 v[64:67], v[56:59], a[48:55], v15
  ds_read_b128 v[100:103], v9 offset:11264
  v_smfmac_f32_16x16x64_bf16 v[68:71], v[56:59], a[112:119], v15
  buffer_load_dwordx4 v11, s[8:11], s37 offen offset:1024 sc1 lds
  v_smfmac_f32_16x16x64_bf16 v[64:67], v[60:63], a[56:63], v15
  ds_read_b128 v[36:39], v10 offset:1024
  v_smfmac_f32_16x16x64_bf16 v[68:71], v[60:63], a[120:127], v15
  ds_read_b128 v[32:35], v10 offset:0
  v_smfmac_f32_16x16x64_bf16 v[72:75], v[40:43], a[144:151], v15
  s_add_u32 s37, s37, 0x40000
  s_add_u32 s40, s40, 0x40000
  v_smfmac_f32_16x16x64_bf16 v[76:79], v[40:43], a[208:215], v15
  s_xor_b32 s38, s38, 0x2000
  s_add_u32 s39, s39, 0x20000
  v_add_f32 v64, v64, v66
  v_smfmac_f32_16x16x64_bf16 v[72:75], v[44:47], a[152:159], v15
  v_add_f32 v65, v65, v67
  v_smfmac_f32_16x16x64_bf16 v[76:79], v[44:47], a[216:223], v15
  v_add_f32 v68, v68, v70
  v_smfmac_f32_16x16x64_bf16 v[72:75], v[48:51], a[160:167], v15
  v_add_f32 v69, v69, v71
  v_smfmac_f32_16x16x64_bf16 v[76:79], v[48:51], a[224:231], v15
  v_mul_f32 v64, s41, v64
  v_smfmac_f32_16x16x64_bf16 v[72:75], v[52:55], a[168:175], v15
  v_mul_f32 v65, s41, v65
  v_smfmac_f32_16x16x64_bf16 v[76:79], v[52:55], a[232:239], v15
  v_mul_f32 v68, s41, v68
  v_smfmac_f32_16x16x64_bf16 v[72:75], v[56:59], a[176:183], v15
  v_mul_f32 v69, s41, v69
  v_smfmac_f32_16x16x64_bf16 v[76:79], v[56:59], a[240:247], v15
  v_cvt_pk_bf16_f32 v64, v64, v65
  v_smfmac_f32_16x16x64_bf16 v[72:75], v[60:63], a[184:191], v15
  v_cvt_pk_bf16_f32 v68, v68, v69
  v_smfmac_f32_16x16x64_bf16 v[76:79], v[60:63], a[248:255], v15
  ds_write2_b32 v6, v64, v68 offset0:0 offset1:32
  v_smfmac_f32_16x16x64_bf16 v[80:83], v[40:43], v[104:111], v15
  ds_read_b128 v[104:107], v9 offset:12288
  v_add_f32 v72, v72, v74
  v_add_f32 v73, v73, v75
  s_nop 0
  v_add_f32 v76, v76, v78
  v_add_f32 v77, v77, v79
  v_cvt_pk_bf16_f32 v16, v72, v73
  v_cvt_pk_bf16_f32 v17, v76, v77
  v_smfmac_f32_16x16x64_bf16 v[84:87], v[40:43], v[112:119], v15
  ds_write2_b32 v6, v16, v17 offset0:1 offset1:33
  s_waitcnt lgkmcnt(3)
  v_smfmac_f32_16x16x64_bf16 v[80:83], v[48:51], v[88:95], v15
  ds_read_b128 v[108:111], v9 offset:13312
  v_smfmac_f32_16x16x64_bf16 v[84:87], v[48:51], v[96:103], v15
  ds_read_b128 v[112:115], v9 offset:14336
  v_mov_b32 v88, 0x3f803f80
  v_smfmac_f32_16x16x64_bf16 v[80:83], v[44:47], v[144:151], v15
  ds_read_b128 v[116:119], v9 offset:15360
  v_mov_b32 v89, 0x3f803f80
  v_smfmac_f32_16x16x64_bf16 v[84:87], v[44:47], v[152:159], v15
  ds_read_b128 v[40:43], v10 offset:2048
  v_mov_b32 v90, 0x3f803f80
  v_smfmac_f32_16x16x64_bf16 v[80:83], v[52:55], v[160:167], v15
  ds_read_b128 v[48:51], v10 offset:3072
  v_mov_b32 v91, 0x3f803f80
  v_smfmac_f32_16x16x64_bf16 v[84:87], v[52:55], v[168:175], v15
  s_waitcnt lgkmcnt(3)
  s_barrier
  ds_read_b64_tr_b16 v[64:65], v7 offset:0
  ds_read_b64_tr_b16 v[66:67], v7 offset:128
  v_smfmac_f32_16x16x64_bf16 v[80:83], v[56:59], v[104:111], v15
  ds_read_b64_tr_b16 v[68:69], v7 offset:1280
  ds_read_b64_tr_b16 v[70:71], v7 offset:1408
  s_waitcnt lgkmcnt(6)
  v_smfmac_f32_16x16x64_bf16 v[84:87], v[56:59], v[112:119], v15
  ds_read_b64_tr_b16 v[72:73], v7 offset:2560
  ds_read_b64_tr_b16 v[74:75], v7 offset:2688
  v_smfmac_f32_16x16x64_bf16 v[80:83], v[60:63], v[176:183], v15
  ds_read_b64_tr_b16 v[76:77], v7 offset:3840
  v_smfmac_f32_16x16x64_bf16 v[84:87], v[60:63], v[184:191], v15
  ds_read_b64_tr_b16 v[78:79], v7 offset:3968
  s_waitcnt lgkmcnt(6)
  v_mfma_f32_16x16x32_bf16 v[116:119], v[64:67], v[64:67], 0
  ds_read_b128 v[44:47], v10 offset:4096
  v_mov_b32 v93, 0
  v_mfma_f32_16x16x32_bf16 v[108:111], v[32:35], v[64:67], 0
  ds_read_b128 v[52:55], v10 offset:5120
  v_add_f32 v80, v80, v82
  s_waitcnt lgkmcnt(4)
  v_mfma_f32_16x16x32_bf16 v[116:119], v[68:71], v[68:71], v[116:119]
  ds_read_b128 v[56:59], v10 offset:6144
  v_add_f32 v81, v81, v83
  v_mfma_f32_16x16x32_bf16 v[108:111], v[36:39], v[68:71], v[108:111]
  ds_read_b128 v[60:63], v10 offset:7168
  v_add_f32 v84, v84, v86
  v_mfma_f32_16x16x32_bf16 v[116:119], v[72:75], v[72:75], v[116:119]
  v_add_f32 v85, v85, v87
  v_mfma_f32_16x16x32_bf16 v[108:111], v[40:43], v[72:75], v[108:111]
  s_waitcnt lgkmcnt(2)
  v_cvt_pk_bf16_f32 v18, v80, v81
  v_cvt_pk_bf16_f32 v19, v84, v85
  v_mfma_f32_16x16x32_bf16 v[116:119], v[76:79], v[76:79], v[116:119]
  s_cmp_ge_u32 s7, 62
  s_cbranch_scc1 Fexit_21
Fbexit_22:
  v_mov_b32 v94, 0
  v_mfma_f32_16x16x32_bf16 v[108:111], v[48:51], v[76:79], v[108:111]
  v_mfma_f32_16x16x32_bf16 v[112:115], v[44:47], v[64:67], 0
  v_exp_f32 v116, v118
  v_mfma_f32_16x16x32_bf16 v[112:115], v[52:55], v[68:71], v[112:115]
  s_waitcnt lgkmcnt(0)
  v_exp_f32 v117, v119
  v_mfma_f32_16x16x32_bf16 v[112:115], v[56:59], v[72:75], v[112:115]
  v_cvt_pk_bf16_f32 v92, v116, v117
  v_cvt_pk_bf16_f32 v95, v116, v117
  v_mfma_f32_16x16x32_bf16 v[112:115], v[60:63], v[76:79], v[112:115]
  v_exp_f32 v100, v108
  v_mfma_f32_16x16x16_bf16 v[96:99], v[92:93], v[88:89], 0
  v_exp_f32 v101, v109
  v_mfma_f32_16x16x16_bf16 v[80:83], v[92:93], v[18:19], 0
  v_exp_f32 v102, v110
  v_mfma_f32_16x16x16_bf16 v[84:87], v[94:95], v[18:19], 0
  v_exp_f32 v103, v111
  v_exp_f32 v104, v112
  v_exp_f32 v105, v113
  v_cvt_pk_bf16_f32 v100, v100, v101
  v_exp_f32 v106, v114
  v_exp_f32 v107, v115
  v_cvt_pk_bf16_f32 v101, v102, v103
  v_cvt_pk_bf16_f32 v102, v104, v105
  v_cvt_pk_bf16_f32 v103, v106, v107
  s_nop 1
  v_mfma_f32_16x16x32_bf16 v[96:99], v[100:103], v[88:91], v[96:99]
  v_mfma_f32_16x16x32_bf16 v[80:83], v[100:103], v[120:123], v[80:83]
  v_mfma_f32_16x16x32_bf16 v[84:87], v[100:103], v[124:127], v[84:87]
  v_rcp_f32 v96, v96
  v_rcp_f32 v97, v97
Fbsm_24:
  s_nop 1
  v_pk_mul_f32 v[80:81], v[80:81], v[96:97]
  v_cvt_pk_bf16_f32 v104, v80, v81
  s_nop 1
  v_pk_mul_f32 v[84:85], v[84:85], v[96:97]
  v_cvt_pk_bf16_f32 v105, v84, v85
  ds_write_b64 v8, v[104:105]
  v_max3_f32 v64, |v108|, |v109|, |v110|
  v_max3_f32 v65, |v111|, |v112|, |v113|
  v_max3_f32 v64, |v114|, |v115|, v64
  v_max3_f32 v65, |v118|, |v119|, v65
  v_mov_b64 v[78:79], 0
  v_max_f32 v64, v64, v65
  v_cmp_lt_f32 vcc, s49, v64
  s_and_b64 vcc, vcc, s[52:53]
  s_cbranch_scc1 Frsm_23
  s_mov_b32 s49, 0x42700000
  v_mfma_f32_32x32x8_bf16 v[32:47], v[78:79], v[78:79], 0
  s_waitcnt lgkmcnt(0)
  s_barrier
  ds_read_b64_tr_b16 v[64:65], v7 offset:5120
  ds_read_b64_tr_b16 v[66:67], v7 offset:5248
  v_mfma_f32_32x32x8_bf16 v[48:63], v[78:79], v[78:79], 0
  ds_read_b64_tr_b16 v[68:69], v7 offset:6400
  ds_read_b64_tr_b16 v[70:71], v7 offset:6528
  ds_read_b128 v[88:91], v13 offset:0
  ds_read_b128 v[92:95], v13 offset:1024
  s_waitcnt lgkmcnt(4)
  v_smfmac_f32_16x16x64_bf16 v[32:35], v[64:67], v[192:199], v15
  ds_read_b128 v[96:99], v13 offset:4096
  v_smfmac_f32_16x16x64_bf16 v[36:39], v[64:67], v[208:215], v15
  ds_read_b128 v[100:103], v13 offset:5120
  s_waitcnt lgkmcnt(4)
  v_smfmac_f32_16x16x64_bf16 v[32:35], v[68:71], v[200:207], v15
  ds_read_b128 v[104:107], v13 offset:2048
  ds_read_b128 v[108:111], v13 offset:3072
  v_smfmac_f32_16x16x64_bf16 v[36:39], v[68:71], v[216:223], v15
  ds_read_b128 v[112:115], v13 offset:6144
  ds_read_b128 v[116:119], v13 offset:7168
  v_smfmac_f32_16x16x64_bf16 v[40:43], v[64:67], v[224:231], v15
  ds_read_b128 v[120:123], v13 offset:8192
  v_add_f32 v32, v32, v34
  v_smfmac_f32_16x16x64_bf16 v[44:47], v[64:67], v[240:247], v15
  ds_read_b128 v[124:127], v13 offset:9216
  v_add_f32 v33, v33, v35
  v_smfmac_f32_16x16x64_bf16 v[40:43], v[68:71], v[232:239], v15
  ds_read_b128 v[80:83], v13 offset:12288
  v_add_f32 v36, v36, v38
  v_add_f32 v37, v37, v39
  v_cvt_pk_bf16_f32 v72, v32, v36
  v_cvt_pk_bf16_f32 v73, v33, v37
  v_and_or_b32 v72, v72, -2, s50
  v_smfmac_f32_16x16x64_bf16 v[44:47], v[68:71], v[248:255], v15
  buffer_store_dwordx2 v[72:73], v12, s[8:11], s32 offen offset:0
  ds_read_b128 v[84:87], v13 offset:13312
  s_waitcnt lgkmcnt(3)
  v_smfmac_f32_16x16x64_bf16 v[48:51], v[64:67], v[88:95], v15
  ds_read_b128 v[88:91], v13 offset:10240
  v_add_f32 v40, v40, v42
  v_smfmac_f32_16x16x64_bf16 v[52:55], v[64:67], v[96:103], v15
  ds_read_b128 v[92:95], v13 offset:11264
  v_add_f32 v41, v41, v43
  v_smfmac_f32_16x16x64_bf16 v[48:51], v[68:71], v[104:111], v15
  ds_read_b128 v[96:99], v13 offset:14336
  ds_read_b128 v[100:103], v13 offset:15360
  v_add_f32 v44, v44, v46
  v_add_f32 v45, v45, v47
  v_cvt_pk_bf16_f32 v74, v40, v44
  v_cvt_pk_bf16_f32 v75, v41, v45
  v_and_or_b32 v74, v74, -2, s50
  v_smfmac_f32_16x16x64_bf16 v[52:55], v[68:71], v[112:119], v15
  buffer_store_dwordx2 v[74:75], v12, s[8:11], s33 offen offset:0
  s_waitcnt lgkmcnt(3)
  v_smfmac_f32_16x16x64_bf16 v[56:59], v[64:67], v[120:127], v15
  v_add_f32 v48, v48, v50
  v_smfmac_f32_16x16x64_bf16 v[60:63], v[64:67], v[80:87], v15
  v_add_f32 v49, v49, v51
  v_add_f32 v52, v52, v54
  v_add_f32 v53, v53, v55
  v_cvt_pk_bf16_f32 v76, v48, v52
  v_cvt_pk_bf16_f32 v77, v49, v53
  v_and_or_b32 v76, v76, -2, s50
  s_waitcnt lgkmcnt(0)
  v_smfmac_f32_16x16x64_bf16 v[56:59], v[68:71], v[88:95], v15
  buffer_store_dwordx2 v[76:77], v12, s[8:11], s56 offen offset:0
  v_smfmac_f32_16x16x64_bf16 v[60:63], v[68:71], v[96:103], v15
  s_nop 3
  v_pk_add_f32 v[56:57], v[56:57], v[58:59]
  s_nop 2
  v_pk_add_f32 v[60:61], v[60:61], v[62:63]
  v_cvt_pk_bf16_f32 v78, v56, v60
  v_cvt_pk_bf16_f32 v79, v57, v61
  v_and_or_b32 v78, v78, -2, s50
  buffer_store_dwordx2 v[78:79], v12, s[8:11], s57 offen offset:0
  s_cmp_eq_u32 s4, 0
  s_cbranch_scc1 Fearly_49
  v_mov_b64 v[64:65], 0
  ds_read_b128 v[88:91], v9 offset:0
  ds_read_b128 v[92:95], v9 offset:1024
  v_mov_b64 v[66:67], 0
  ds_read_b128 v[96:99], v9 offset:2048
  ds_read_b128 v[100:103], v9 offset:3072
  v_mov_b64 v[68:69], 0
  ds_read_b128 v[104:107], v9 offset:4096
  ds_read_b128 v[108:111], v9 offset:5120
  v_mov_b64 v[70:71], 0
  ds_read_b128 v[112:115], v9 offset:6144
  ds_read_b128 v[116:119], v9 offset:7168
  v_mov_b64 v[72:73], 0
  s_mov_b32 s51, s35
  s_xor_b32 s35, s35, 0x2000
  s_xor_b32 s32, s32, 0x40000
  v_mov_b64 v[74:75], 0
  s_xor_b32 s33, s33, 0x40000
  s_xor_b32 s56, s56, 0x40000
  s_xor_b32 s57, s57, 0x40000
  v_mov_b64 v[76:77], 0
  s_xor_b32 s36, s36, 0x2000
  s_add_u32 s7, s7, 1
  s_mov_b32 m0, s38
  v_mov_b64 v[78:79], 0
  s_mov_b32 s42, 0
  v_mov_b64 v[80:81], 0
  v_mov_b64 v[82:83], 0
  v_mov_b64 v[84:85], 0
  v_mov_b64 v[86:87], 0
  v_xor_b32 v10, 0x2000, v10
  v_mov_b32 v126, -1
  s_nop 5
  s_cmp_lg_u32 s4, 1
  s_cbranch_scc1 Fidle_47
  buffer_load_dwordx4 v[48:51], v11, s[8:11], s34 offen offset:0 sc1
  buffer_load_dwordx4 v[52:55], v11, s[8:11], s34 offen offset:1024 sc1
  buffer_load_dwordx4 v[56:59], v11, s[8:11], s34 offen offset:2048 sc1
  buffer_load_dwordx4 v[60:63], v11, s[8:11], s34 offen offset:3072 sc1
  s_nop 15
  s_nop 11
  buffer_load_dwordx4 v[32:35], v11, s[8:11], s34 offen offset:0 sc1
  buffer_load_dwordx4 v[36:39], v11, s[8:11], s34 offen offset:1024 sc1
  buffer_load_dwordx4 v[40:43], v11, s[8:11], s34 offen offset:2048 sc1
  buffer_load_dwordx4 v[44:47], v11, s[8:11], s34 offen offset:3072 sc1
Flp1_44:
  s_waitcnt vmcnt(7)
  v_mfma_f32_16x16x32_bf16 v[120:123], v[20:23], v[48:51], 0
  s_waitcnt vmcnt(6)
  v_mfma_f32_16x16x32_bf16 v[120:123], v[20:23], v[52:55], v[120:123]
  v_bitop3_b32 v124, v48, v52, s50 bitop3:0x7e
  s_waitcnt vmcnt(5)
  v_mfma_f32_16x16x32_bf16 v[120:123], v[20:23], v[56:59], v[120:123]
  s_waitcnt vmcnt(4)
  v_mfma_f32_16x16x32_bf16 v[120:123], v[20:23], v[60:63], v[120:123]
  v_bitop3_b32 v125, v56, v60, s50 bitop3:0x7e
  v_bitop3_b32 v124, v124, v125, 1 bitop3:0xa8
  v_cmp_ne_u32 vcc, 0, v124
  s_nop 4
  v_add_f32_dpp v120, v120, v120 row_ror:8 row_mask:0xf bank_mask:0xf
  v_add_f32_dpp v121, v121, v121 row_ror:8 row_mask:0xf bank_mask:0xf
  v_cvt_pk_bf16_f32 v120, v120, v121
  s_cbranch_vccnz Fr1_41
Fok1_40:
  buffer_store_dword v120, v14, s[8:11], s35 offen
  buffer_store_dword v126, v14, s[8:11], s51 offen
Fj2_48:
  s_barrier
  s_nop 12
  buffer_load_dwordx4 v[32:35], v11, s[8:11], s36 offen sc1
  buffer_load_dwordx4 v[36:39], v11, s[8:11], s36 offen offset:1024 sc1
  v_mov_b64 v[120:121], v[24:25]
  s_xor_b32 s34, s34, 0x40000
  s_bfe_u32 s50, s7, 0x10001
  s_mov_b32 s42, 0
  v_mov_b64 v[122:123], v[26:27]
  v_mov_b64 v[124:125], v[28:29]
  v_mov_b64 v[126:127], v[30:31]
  s_nop 15
  s_nop 8
  buffer_load_dwordx4 v[24:27], v11, s[8:11], s36 offen sc1
  buffer_load_dwordx4 v[28:31], v11, s[8:11], s36 offen offset:1024 sc1
  s_add_u32 s43, s7, 1
  v_cmp_ge_u32 vcc, s43, v1
  s_cbranch_vccnz Frkv_25
Fbkv_26:
  s_add_u32 s43, s7, 4
  v_cmp_ge_u32 vcc, s43, v1
  s_or_b32 s55, vcc_lo, vcc_hi
  s_mov_b32 s42, 0
  s_waitcnt lgkmcnt(0)
  s_branch Fpoll_35
Fto_31:
  s_mov_b32 s6, 0
  s_waitcnt vmcnt(0)
  ds_write_b128 v2, v[32:35]
  s_branch Fs0v_32
Fearly_49:
  v_mov_b64 v[64:65], 0
  ds_read_b128 v[88:91], v9 offset:0
  ds_read_b128 v[92:95], v9 offset:1024
  v_mov_b64 v[66:67], 0
  ds_read_b128 v[96:99], v9 offset:2048
  ds_read_b128 v[100:103], v9 offset:3072
  v_mov_b64 v[68:69], 0
  ds_read_b128 v[104:107], v9 offset:4096
  ds_read_b128 v[108:111], v9 offset:5120
  v_mov_b64 v[70:71], 0
  ds_read_b128 v[112:115], v9 offset:6144
  ds_read_b128 v[116:119], v9 offset:7168
  v_mov_b64 v[72:73], 0
  s_mov_b32 s51, s35
  s_xor_b32 s35, s35, 0x2000
  s_xor_b32 s32, s32, 0x40000
  v_mov_b64 v[74:75], 0
  s_xor_b32 s33, s33, 0x40000
  s_xor_b32 s56, s56, 0x40000
  s_xor_b32 s57, s57, 0x40000
  v_mov_b64 v[76:77], 0
  buffer_load_dwordx4 v[48:51], v11, s[8:11], s34 offen offset:0 sc1
  buffer_load_dwordx4 v[52:55], v11, s[8:11], s34 offen offset:1024 sc1
  buffer_load_dwordx4 v[56:59], v11, s[8:11], s34 offen offset:2048 sc1
  buffer_load_dwordx4 v[60:63], v11, s[8:11], s34 offen offset:3072 sc1
  v_mov_b64 v[78:79], 0
  v_mov_b64 v[80:81], 0
  v_mov_b64 v[82:83], 0
  v_mov_b64 v[84:85], 0
  v_mov_b64 v[86:87], 0
  v_xor_b32 v10, 0x2000, v10
  v_mov_b32 v126, -1
  s_xor_b32 s36, s36, 0x2000
  s_add_u32 s7, s7, 1
  s_mov_b32 m0, s38
  s_mov_b32 s42, 0
  s_waitcnt vmcnt(3)
  v_mfma_f32_16x16x32_bf16 v[120:123], v[20:23], v[48:51], 0
  s_waitcnt vmcnt(2)
  v_mfma_f32_16x16x32_bf16 v[120:123], v[20:23], v[52:55], v[120:123]
  v_bitop3_b32 v124, v48, v52, s50 bitop3:0x7e
  s_waitcnt vmcnt(1)
  v_mfma_f32_16x16x32_bf16 v[120:123], v[20:23], v[56:59], v[120:123]
  s_waitcnt vmcnt(0)
  v_mfma_f32_16x16x32_bf16 v[120:123], v[20:23], v[60:63], v[120:123]
  v_bitop3_b32 v125, v56, v60, s50 bitop3:0x7e
  v_bitop3_b32 v124, v124, v125, 1 bitop3:0xa8
  v_cmp_ne_u32 vcc, 0, v124
  s_nop 4
  v_add_f32_dpp v120, v120, v120 row_ror:8 row_mask:0xf bank_mask:0xf
  v_add_f32_dpp v121, v121, v121 row_ror:8 row_mask:0xf bank_mask:0xf
  v_cvt_pk_bf16_f32 v120, v120, v121
  s_cbranch_vccz Fok1_40
  buffer_load_dwordx4 v[48:51], v11, s[8:11], s34 offen offset:0 sc1
  buffer_load_dwordx4 v[52:55], v11, s[8:11], s34 offen offset:1024 sc1
  buffer_load_dwordx4 v[56:59], v11, s[8:11], s34 offen offset:2048 sc1
  buffer_load_dwordx4 v[60:63], v11, s[8:11], s34 offen offset:3072 sc1
  s_nop 15
  s_nop 7
  buffer_load_dwordx4 v[32:35], v11, s[8:11], s34 offen offset:0 sc1
  buffer_load_dwordx4 v[36:39], v11, s[8:11], s34 offen offset:1024 sc1
  buffer_load_dwordx4 v[40:43], v11, s[8:11], s34 offen offset:2048 sc1
  buffer_load_dwordx4 v[44:47], v11, s[8:11], s34 offen offset:3072 sc1
  s_branch Flp1_44
Fidle_47:
  s_waitcnt vmcnt(0)
  s_branch Fj2_48
Fr1_41:
  buffer_load_dwordx4 v[48:51], v11, s[8:11], s34 offen offset:0 sc1
  buffer_load_dwordx4 v[52:55], v11, s[8:11], s34 offen offset:1024 sc1
  buffer_load_dwordx4 v[56:59], v11, s[8:11], s34 offen offset:2048 sc1
  buffer_load_dwordx4 v[60:63], v11, s[8:11], s34 offen offset:3072 sc1
  s_waitcnt vmcnt(7)
  v_mfma_f32_16x16x32_bf16 v[120:123], v[20:23], v[32:35], 0
  s_waitcnt vmcnt(6)
  v_mfma_f32_16x16x32_bf16 v[120:123], v[20:23], v[36:39], v[120:123]
  v_bitop3_b32 v124, v32, v36, s50 bitop3:0x7e
  s_waitcnt vmcnt(5)
  v_mfma_f32_16x16x32_bf16 v[120:123], v[20:23], v[40:43], v[120:123]
  s_waitcnt vmcnt(4)
  v_mfma_f32_16x16x32_bf16 v[120:123], v[20:23], v[44:47], v[120:123]
  v_bitop3_b32 v125, v40, v44, s50 bitop3:0x7e
  v_bitop3_b32 v124, v124, v125, 1 bitop3:0xa8
  v_cmp_ne_u32 vcc, 0, v124
  s_nop 4
  v_add_f32_dpp v120, v120, v120 row_ror:8 row_mask:0xf bank_mask:0xf
  v_add_f32_dpp v121, v121, v121 row_ror:8 row_mask:0xf bank_mask:0xf
  v_cvt_pk_bf16_f32 v120, v120, v121
  s_cbranch_vccz Fok1_40
  buffer_load_dwordx4 v[32:35], v11, s[8:11], s34 offen offset:0 sc1
  buffer_load_dwordx4 v[36:39], v11, s[8:11], s34 offen offset:1024 sc1
  buffer_load_dwordx4 v[40:43], v11, s[8:11], s34 offen offset:2048 sc1
  buffer_load_dwordx4 v[44:47], v11, s[8:11], s34 offen offset:3072 sc1
  s_add_u32 s42, s42, 1
  s_cmp_lt_u32 s42, s6
  s_cbranch_scc1 Flp1_44
  s_mov_b32 s6, 0
  s_branch Fok1_40
Frqf_38:
  buffer_load_dword v1, v0, s[8:11], s46 offen sc1
  s_branch Fbqf_39
Frkv_25:
  s_mov_b32 s42, 0
  s_add_u32 s43, s7, 1
kvr_50:
  buffer_load_dword v1, v0, s[8:11], s46 offen sc1
  s_waitcnt vmcnt(0)
  v_cmp_ge_u32 vcc, s43, v1
  s_cbranch_vccz kvok_51
  s_sleep 2
  s_add_u32 s42, s42, 1
  s_cmp_lt_u32 s42, s6
  s_cbranch_scc1 kvr_50
  s_mov_b32 s6, 0
kvok_51:
  s_branch Fbkv_26
Frsm_23:
  v_max3_f32 v64, v108, v109, v110
  v_max3_f32 v64, v111, v112, v64
  v_max3_f32 v64, v113, v114, v64
  v_max3_f32 v64, v115, v118, v64
  v_max_f32 v64, v119, v64
  v_mov_b32 v65, v64
  s_nop 1
  v_permlane32_swap_b32 v64, v65
  v_max_f32 v64, v64, v65
  v_mov_b32 v65, v64
  s_nop 1
  v_permlane16_swap_b32 v64, v65
  v_max_f32 v64, v64, v65
  v_sub_f32 v108, v108, v64
  v_sub_f32 v109, v109, v64
  v_sub_f32 v110, v110, v64
  v_sub_f32 v111, v111, v64
  v_sub_f32 v112, v112, v64
  v_sub_f32 v113, v113, v64
  v_sub_f32 v114, v114, v64
  v_sub_f32 v115, v115, v64
  v_sub_f32 v118, v118, v64
  v_sub_f32 v119, v119, v64
  v_exp_f32 v100, v108
  v_exp_f32 v101, v109
  v_exp_f32 v102, v110
  v_exp_f32 v103, v111
  v_exp_f32 v104, v112
  v_exp_f32 v105, v113
  v_exp_f32 v106, v114
  v_exp_f32 v107, v115
  v_exp_f32 v116, v118
  v_exp_f32 v117, v119
  v_cvt_pk_bf16_f32 v100, v100, v101
  v_cvt_pk_bf16_f32 v101, v102, v103
  v_cvt_pk_bf16_f32 v102, v104, v105
  v_cvt_pk_bf16_f32 v103, v106, v107
  v_cvt_pk_bf16_f32 v92, v116, v117
  v_cvt_pk_bf16_f32 v95, v116, v117
  s_nop 0
  v_mfma_f32_16x16x16_bf16 v[96:99], v[92:93], v[88:89], 0
  v_mfma_f32_16x16x16_bf16 v[80:83], v[92:93], v[18:19], 0
  v_mfma_f32_16x16x16_bf16 v[84:87], v[94:95], v[18:19], 0
  v_mfma_f32_16x16x32_bf16 v[96:99], v[100:103], v[88:91], v[96:99]
  v_mfma_f32_16x16x32_bf16 v[80:83], v[100:103], v[120:123], v[80:83]
  v_mfma_f32_16x16x32_bf16 v[84:87], v[100:103], v[124:127], v[84:87]
  s_mov_b32 s49, 0x7f800000
  v_rcp_f32 v96, v96
  v_rcp_f32 v97, v97
  s_waitcnt lgkmcnt(0)
  s_branch Fbsm_24
Fexit_21:
  buffer_store_dwordx4 v[16:19], v11, s[8:11], s39 offen sc1
  s_cmp_lt_u32 s7, 63
  s_cbranch_scc1 Fbexit_22
  s_waitcnt lgkmcnt(0)
CWe_6:
  s_branch CHdone_20
CHslow_19:
  ds_write_b128 v2, v[32:35]
  s_branch Ss0v_63
.p2align 6
  s_nop 0
Ss0f_60:
  v_max_u32 v52, v35, v39
  v_cmp_eq_u32 vcc, -1, v52
  s_cbranch_vccz Ss0v_63
  buffer_load_dwordx4 v[32:35], v11, s[8:11], s36 offen sc1
  buffer_load_dwordx4 v[36:39], v11, s[8:11], s36 offen offset:1024 sc1
  s_add_u32 s42, s42, 1
  s_cmp_ge_u32 s42, s6
  s_cbranch_scc1 Sto_62
  s_waitcnt vmcnt(3)
  ds_write_b128 v2, v[24:27]
Sar2_67:
  s_waitcnt vmcnt(2)
  v_cmp_u_f32 vcc, v27, v31
  s_cbranch_vccnz Ss0f_61
Ss0v_64:
  v_smfmac_f32_16x16x64_bf16 v[64:67], v[24:27], a[0:7], v15
  v_smfmac_f32_16x16x64_bf16 v[68:71], v[24:27], a[64:71], v15
  v_smfmac_f32_16x16x64_bf16 v[72:75], v[24:27], a[128:135], v15
  ds_write_b128 v2, v[28:31] offset:1024
  v_smfmac_f32_16x16x64_bf16 v[76:79], v[24:27], a[192:199], v15
  v_smfmac_f32_16x16x64_bf16 v[64:67], v[28:31], a[8:15], v15
  v_smfmac_f32_16x16x64_bf16 v[68:71], v[28:31], a[72:79], v15
  v_smfmac_f32_16x16x64_bf16 v[72:75], v[28:31], a[136:143], v15
  s_waitcnt lgkmcnt(0)
  s_barrier
  ds_read_b128 v[40:43], v3 offset:0
  v_smfmac_f32_16x16x64_bf16 v[76:79], v[28:31], a[200:207], v15
  ds_read_b128 v[44:47], v3 offset:1024
  v_smfmac_f32_16x16x64_bf16 v[80:83], v[24:27], v[88:95], v15
  ds_read_b128 v[48:51], v4 offset:0
  v_smfmac_f32_16x16x64_bf16 v[84:87], v[24:27], v[96:103], v15
  ds_read_b128 v[52:55], v4 offset:1024
  v_smfmac_f32_16x16x64_bf16 v[80:83], v[28:31], v[128:135], v15
  ds_read_b128 v[56:59], v5 offset:0
  v_smfmac_f32_16x16x64_bf16 v[84:87], v[28:31], v[136:143], v15
  ds_read_b128 v[60:63], v5 offset:1024
  s_branch Scom_65
.p2align 6
  s_nop 0
Ss0f_61:
  v_max_u32 v52, v27, v31
  v_cmp_eq_u32 vcc, -1, v52
  s_cbranch_vccz Ss0v_64
  buffer_load_dwordx4 v[24:27], v11, s[8:11], s36 offen sc1
  buffer_load_dwordx4 v[28:31], v11, s[8:11], s36 offen offset:1024 sc1
  s_add_u32 s42, s42, 1
  s_cmp_ge_u32 s42, s6
  s_cbranch_scc1 Sto_62
Spoll_66:
  s_waitcnt vmcnt(3)
  ds_write_b128 v2, v[32:35]
Sar2_68:
  s_waitcnt vmcnt(2)
  v_cmp_u_f32 vcc, v35, v39
  s_cbranch_vccnz Ss0f_60
Ss0v_63:
  v_smfmac_f32_16x16x64_bf16 v[64:67], v[32:35], a[0:7], v15
  v_smfmac_f32_16x16x64_bf16 v[68:71], v[32:35], a[64:71], v15
  v_smfmac_f32_16x16x64_bf16 v[72:75], v[32:35], a[128:135], v15
  ds_write_b128 v2, v[36:39] offset:1024
  v_smfmac_f32_16x16x64_bf16 v[76:79], v[32:35], a[192:199], v15
  v_smfmac_f32_16x16x64_bf16 v[64:67], v[36:39], a[8:15], v15
  v_smfmac_f32_16x16x64_bf16 v[68:71], v[36:39], a[72:79], v15
  v_smfmac_f32_16x16x64_bf16 v[72:75], v[36:39], a[136:143], v15
  s_waitcnt lgkmcnt(0)
  s_barrier
  ds_read_b128 v[40:43], v3 offset:0
  v_smfmac_f32_16x16x64_bf16 v[76:79], v[36:39], a[200:207], v15
  ds_read_b128 v[44:47], v3 offset:1024
  v_smfmac_f32_16x16x64_bf16 v[80:83], v[32:35], v[88:95], v15
  ds_read_b128 v[48:51], v4 offset:0
  v_smfmac_f32_16x16x64_bf16 v[84:87], v[32:35], v[96:103], v15
  ds_read_b128 v[52:55], v4 offset:1024
  v_smfmac_f32_16x16x64_bf16 v[80:83], v[36:39], v[128:135], v15
  ds_read_b128 v[56:59], v5 offset:0
  v_smfmac_f32_16x16x64_bf16 v[84:87], v[36:39], v[136:143], v15
  ds_read_b128 v[60:63], v5 offset:1024
Scom_65:
  s_waitcnt lgkmcnt(4)
  v_smfmac_f32_16x16x64_bf16 v[64:67], v[40:43], a[16:23], v15
  s_waitcnt vmcnt(0)
  buffer_store_dwordx4 v[16:19], v11, s[8:11], s39 offen sc1
  v_smfmac_f32_16x16x64_bf16 v[68:71], v[40:43], a[80:87], v15
  s_cmp_lg_u32 s55, 0
  s_cbranch_scc1 Srqf_69
Sbqf_70:
  v_smfmac_f32_16x16x64_bf16 v[64:67], v[44:47], a[24:31], v15
  ds_read_b128 v[88:91], v9 offset:8192
  v_smfmac_f32_16x16x64_bf16 v[68:71], v[44:47], a[88:95], v15
  buffer_load_dwordx4 v[24:27], v11, s[8:11], s40 offen sc1
  s_waitcnt lgkmcnt(1)
  v_smfmac_f32_16x16x64_bf16 v[64:67], v[48:51], a[32:39], v15
  ds_read_b128 v[92:95], v9 offset:9216
  v_smfmac_f32_16x16x64_bf16 v[68:71], v[48:51], a[96:103], v15
  buffer_load_dwordx4 v[28:31], v11, s[8:11], s40 offen offset:1024 sc1
  v_smfmac_f32_16x16x64_bf16 v[64:67], v[52:55], a[40:47], v15
  ds_read_b128 v[96:99], v9 offset:10240
  v_smfmac_f32_16x16x64_bf16 v[68:71], v[52:55], a[104:111], v15
  buffer_load_dwordx4 v11, s[8:11], s37 offen sc1 lds
  v_smfmac_f32_16x16x64_bf16 v[64:67], v[56:59], a[48:55], v15
  ds_read_b128 v[100:103], v9 offset:11264
  v_smfmac_f32_16x16x64_bf16 v[68:71], v[56:59], a[112:119], v15
  buffer_load_dwordx4 v11, s[8:11], s37 offen offset:1024 sc1 lds
  v_smfmac_f32_16x16x64_bf16 v[64:67], v[60:63], a[56:63], v15
  ds_read_b128 v[36:39], v10 offset:1024
  v_smfmac_f32_16x16x64_bf16 v[68:71], v[60:63], a[120:127], v15
  ds_read_b128 v[32:35], v10 offset:0
  v_smfmac_f32_16x16x64_bf16 v[72:75], v[40:43], a[144:151], v15
  s_add_u32 s37, s37, 0x40000
  s_add_u32 s40, s40, 0x40000
  v_smfmac_f32_16x16x64_bf16 v[76:79], v[40:43], a[208:215], v15
  s_xor_b32 s38, s38, 0x2000
  s_add_u32 s39, s39, 0x20000
  v_add_f32 v64, v64, v66
  v_smfmac_f32_16x16x64_bf16 v[72:75], v[44:47], a[152:159], v15
  v_add_f32 v65, v65, v67
  v_smfmac_f32_16x16x64_bf16 v[76:79], v[44:47], a[216:223], v15
  v_add_f32 v68, v68, v70
  v_smfmac_f32_16x16x64_bf16 v[72:75], v[48:51], a[160:167], v15
  v_add_f32 v69, v69, v71
  v_smfmac_f32_16x16x64_bf16 v[76:79], v[48:51], a[224:231], v15
  v_mul_f32 v64, s41, v64
  v_smfmac_f32_16x16x64_bf16 v[72:75], v[52:55], a[168:175], v15
  v_mul_f32 v65, s41, v65
  v_smfmac_f32_16x16x64_bf16 v[76:79], v[52:55], a[232:239], v15
  v_mul_f32 v68, s41, v68
  v_smfmac_f32_16x16x64_bf16 v[72:75], v[56:59], a[176:183], v15
  v_mul_f32 v69, s41, v69
  v_smfmac_f32_16x16x64_bf16 v[76:79], v[56:59], a[240:247], v15
  v_cvt_pk_bf16_f32 v64, v64, v65
  v_smfmac_f32_16x16x64_bf16 v[72:75], v[60:63], a[184:191], v15
  v_cvt_pk_bf16_f32 v68, v68, v69
  v_smfmac_f32_16x16x64_bf16 v[76:79], v[60:63], a[248:255], v15
  ds_write2_b32 v6, v64, v68 offset0:0 offset1:32
  v_smfmac_f32_16x16x64_bf16 v[80:83], v[40:43], v[104:111], v15
  ds_read_b128 v[104:107], v9 offset:12288
  v_add_f32 v72, v72, v74
  v_add_f32 v73, v73, v75
  s_nop 0
  v_add_f32 v76, v76, v78
  v_add_f32 v77, v77, v79
  v_cvt_pk_bf16_f32 v16, v72, v73
  v_cvt_pk_bf16_f32 v17, v76, v77
  v_smfmac_f32_16x16x64_bf16 v[84:87], v[40:43], v[112:119], v15
  ds_write2_b32 v6, v16, v17 offset0:1 offset1:33
  s_waitcnt lgkmcnt(3)
  v_smfmac_f32_16x16x64_bf16 v[80:83], v[48:51], v[88:95], v15
  ds_read_b128 v[108:111], v9 offset:13312
  v_smfmac_f32_16x16x64_bf16 v[84:87], v[48:51], v[96:103], v15
  ds_read_b128 v[112:115], v9 offset:14336
  v_mov_b32 v88, 0x3f803f80
  v_smfmac_f32_16x16x64_bf16 v[80:83], v[44:47], v[144:151], v15
  ds_read_b128 v[116:119], v9 offset:15360
  v_mov_b32 v89, 0x3f803f80
  v_smfmac_f32_16x16x64_bf16 v[84:87], v[44:47], v[152:159], v15
  ds_read_b128 v[40:43], v10 offset:2048
  v_mov_b32 v90, 0x3f803f80
  v_smfmac_f32_16x16x64_bf16 v[80:83], v[52:55], v[160:167], v15
  ds_read_b128 v[48:51], v10 offset:3072
  v_mov_b32 v91, 0x3f803f80
  v_smfmac_f32_16x16x64_bf16 v[84:87], v[52:55], v[168:175], v15
  s_waitcnt lgkmcnt(3)
  s_barrier
  ds_read_b64_tr_b16 v[64:65], v7 offset:0
  ds_read_b64_tr_b16 v[66:67], v7 offset:128
  v_smfmac_f32_16x16x64_bf16 v[80:83], v[56:59], v[104:111], v15
  ds_read_b64_tr_b16 v[68:69], v7 offset:1280
  ds_read_b64_tr_b16 v[70:71], v7 offset:1408
  s_waitcnt lgkmcnt(6)
  v_smfmac_f32_16x16x64_bf16 v[84:87], v[56:59], v[112:119], v15
  ds_read_b64_tr_b16 v[72:73], v7 offset:2560
  ds_read_b64_tr_b16 v[74:75], v7 offset:2688
  v_smfmac_f32_16x16x64_bf16 v[80:83], v[60:63], v[176:183], v15
  ds_read_b64_tr_b16 v[76:77], v7 offset:3840
  v_smfmac_f32_16x16x64_bf16 v[84:87], v[60:63], v[184:191], v15
  ds_read_b64_tr_b16 v[78:79], v7 offset:3968
  s_waitcnt lgkmcnt(6)
  v_mfma_f32_16x16x32_bf16 v[116:119], v[64:67], v[64:67], 0
  ds_read_b128 v[44:47], v10 offset:4096
  v_mov_b32 v93, 0
  v_mfma_f32_16x16x32_bf16 v[108:111], v[32:35], v[64:67], 0
  ds_read_b128 v[52:55], v10 offset:5120
  v_add_f32 v80, v80, v82
  s_waitcnt lgkmcnt(4)
  v_mfma_f32_16x16x32_bf16 v[116:119], v[68:71], v[68:71], v[116:119]
  ds_read_b128 v[56:59], v10 offset:6144
  v_add_f32 v81, v81, v83
  v_mfma_f32_16x16x32_bf16 v[108:111], v[36:39], v[68:71], v[108:111]
  ds_read_b128 v[60:63], v10 offset:7168
  v_add_f32 v84, v84, v86
  v_mfma_f32_16x16x32_bf16 v[116:119], v[72:75], v[72:75], v[116:119]
  v_add_f32 v85, v85, v87
  v_mfma_f32_16x16x32_bf16 v[108:111], v[40:43], v[72:75], v[108:111]
  s_waitcnt lgkmcnt(2)
  v_cvt_pk_bf16_f32 v18, v80, v81
  v_cvt_pk_bf16_f32 v19, v84, v85
  v_mfma_f32_16x16x32_bf16 v[116:119], v[76:79], v[76:79], v[116:119]
  s_cmp_ge_u32 s7, 62
  s_cbranch_scc1 Sexit_52
Sbexit_53:
  v_mov_b32 v94, 0
  v_mfma_f32_16x16x32_bf16 v[108:111], v[48:51], v[76:79], v[108:111]
  v_mfma_f32_16x16x32_bf16 v[112:115], v[44:47], v[64:67], 0
  v_exp_f32 v116, v118
  v_mfma_f32_16x16x32_bf16 v[112:115], v[52:55], v[68:71], v[112:115]
  s_waitcnt lgkmcnt(0)
  v_exp_f32 v117, v119
  v_mfma_f32_16x16x32_bf16 v[112:115], v[56:59], v[72:75], v[112:115]
  v_cvt_pk_bf16_f32 v92, v116, v117
  v_cvt_pk_bf16_f32 v95, v116, v117
  v_mfma_f32_16x16x32_bf16 v[112:115], v[60:63], v[76:79], v[112:115]
  v_exp_f32 v100, v108
  v_mfma_f32_16x16x16_bf16 v[96:99], v[92:93], v[88:89], 0
  v_exp_f32 v101, v109
  v_mfma_f32_16x16x16_bf16 v[80:83], v[92:93], v[18:19], 0
  v_exp_f32 v102, v110
  v_mfma_f32_16x16x16_bf16 v[84:87], v[94:95], v[18:19], 0
  v_exp_f32 v103, v111
  v_exp_f32 v104, v112
  v_exp_f32 v105, v113
  v_cvt_pk_bf16_f32 v100, v100, v101
  v_exp_f32 v106, v114
  v_exp_f32 v107, v115
  v_cvt_pk_bf16_f32 v101, v102, v103
  v_cvt_pk_bf16_f32 v102, v104, v105
  v_cvt_pk_bf16_f32 v103, v106, v107
  s_nop 1
  v_mfma_f32_16x16x32_bf16 v[96:99], v[100:103], v[88:91], v[96:99]
  v_mfma_f32_16x16x32_bf16 v[80:83], v[100:103], v[120:123], v[80:83]
  v_mfma_f32_16x16x32_bf16 v[84:87], v[100:103], v[124:127], v[84:87]
  v_rcp_f32 v96, v96
  v_rcp_f32 v97, v97
Sbsm_55:
  s_nop 1
  v_pk_mul_f32 v[80:81], v[80:81], v[96:97]
  v_cvt_pk_bf16_f32 v104, v80, v81
  s_nop 1
  v_pk_mul_f32 v[84:85], v[84:85], v[96:97]
  v_cvt_pk_bf16_f32 v105, v84, v85
  ds_write_b64 v8, v[104:105]
  v_max3_f32 v64, |v108|, |v109|, |v110|
  v_max3_f32 v65, |v111|, |v112|, |v113|
  v_max3_f32 v64, |v114|, |v115|, v64
  v_max3_f32 v65, |v118|, |v119|, v65
  v_mov_b64 v[78:79], 0
  v_max_f32 v64, v64, v65
  v_cmp_lt_f32 vcc, s49, v64
  s_and_b64 vcc, vcc, s[52:53]
  s_cbranch_scc1 Srsm_54
  s_mov_b32 s49, 0x42700000
  v_mfma_f32_32x32x8_bf16 v[32:47], v[78:79], v[78:79], 0
  s_waitcnt lgkmcnt(0)
  s_barrier
  ds_read_b64_tr_b16 v[64:65], v7 offset:5120
  ds_read_b64_tr_b16 v[66:67], v7 offset:5248
  v_mfma_f32_32x32x8_bf16 v[48:63], v[78:79], v[78:79], 0
  ds_read_b64_tr_b16 v[68:69], v7 offset:6400
  ds_read_b64_tr_b16 v[70:71], v7 offset:6528
  ds_read_b128 v[88:91], v13 offset:0
  ds_read_b128 v[92:95], v13 offset:1024
  s_waitcnt lgkmcnt(4)
  v_smfmac_f32_16x16x64_bf16 v[32:35], v[64:67], v[192:199], v15
  ds_read_b128 v[96:99], v13 offset:4096
  v_smfmac_f32_16x16x64_bf16 v[36:39], v[64:67], v[208:215], v15
  ds_read_b128 v[100:103], v13 offset:5120
  s_waitcnt lgkmcnt(4)
  v_smfmac_f32_16x16x64_bf16 v[32:35], v[68:71], v[200:207], v15
  ds_read_b128 v[104:107], v13 offset:2048
  ds_read_b128 v[108:111], v13 offset:3072
  v_smfmac_f32_16x16x64_bf16 v[36:39], v[68:71], v[216:223], v15
  ds_read_b128 v[112:115], v13 offset:6144
  ds_read_b128 v[116:119], v13 offset:7168
  v_smfmac_f32_16x16x64_bf16 v[40:43], v[64:67], v[224:231], v15
  ds_read_b128 v[120:123], v13 offset:8192
  v_add_f32 v32, v32, v34
  v_smfmac_f32_16x16x64_bf16 v[44:47], v[64:67], v[240:247], v15
  ds_read_b128 v[124:127], v13 offset:9216
  v_add_f32 v33, v33, v35
  v_smfmac_f32_16x16x64_bf16 v[40:43], v[68:71], v[232:239], v15
  ds_read_b128 v[80:83], v13 offset:12288
  v_add_f32 v36, v36, v38
  v_add_f32 v37, v37, v39
  v_cvt_pk_bf16_f32 v72, v32, v36
  v_cvt_pk_bf16_f32 v73, v33, v37
  v_and_or_b32 v72, v72, -2, s50
  v_smfmac_f32_16x16x64_bf16 v[44:47], v[68:71], v[248:255], v15
  buffer_store_dwordx2 v[72:73], v12, s[8:11], s32 offen offset:0 sc1
  ds_read_b128 v[84:87], v13 offset:13312
  s_waitcnt lgkmcnt(3)
  v_smfmac_f32_16x16x64_bf16 v[48:51], v[64:67], v[88:95], v15
  ds_read_b128 v[88:91], v13 offset:10240
  v_add_f32 v40, v40, v42
  v_smfmac_f32_16x16x64_bf16 v[52:55], v[64:67], v[96:103], v15
  ds_read_b128 v[92:95], v13 offset:11264
  v_add_f32 v41, v41, v43
  v_smfmac_f32_16x16x64_bf16 v[48:51], v[68:71], v[104:111], v15
  ds_read_b128 v[96:99], v13 offset:14336
  ds_read_b128 v[100:103], v13 offset:15360
  v_add_f32 v44, v44, v46
  v_add_f32 v45, v45, v47
  v_cvt_pk_bf16_f32 v74, v40, v44
  v_cvt_pk_bf16_f32 v75, v41, v45
  v_and_or_b32 v74, v74, -2, s50
  v_smfmac_f32_16x16x64_bf16 v[52:55], v[68:71], v[112:119], v15
  buffer_store_dwordx2 v[74:75], v12, s[8:11], s33 offen offset:0 sc1
  s_waitcnt lgkmcnt(3)
  v_smfmac_f32_16x16x64_bf16 v[56:59], v[64:67], v[120:127], v15
  v_add_f32 v48, v48, v50
  v_smfmac_f32_16x16x64_bf16 v[60:63], v[64:67], v[80:87], v15
  v_add_f32 v49, v49, v51
  v_add_f32 v52, v52, v54
  v_add_f32 v53, v53, v55
  v_cvt_pk_bf16_f32 v76, v48, v52
  v_cvt_pk_bf16_f32 v77, v49, v53
  v_and_or_b32 v76, v76, -2, s50
  s_waitcnt lgkmcnt(0)
  v_smfmac_f32_16x16x64_bf16 v[56:59], v[68:71], v[88:95], v15
  buffer_store_dwordx2 v[76:77], v12, s[8:11], s56 offen offset:0 sc1
  v_smfmac_f32_16x16x64_bf16 v[60:63], v[68:71], v[96:103], v15
  s_nop 3
  v_pk_add_f32 v[56:57], v[56:57], v[58:59]
  s_nop 2
  v_pk_add_f32 v[60:61], v[60:61], v[62:63]
  v_cvt_pk_bf16_f32 v78, v56, v60
  v_cvt_pk_bf16_f32 v79, v57, v61
  v_and_or_b32 v78, v78, -2, s50
  buffer_store_dwordx2 v[78:79], v12, s[8:11], s57 offen offset:0 sc1
  s_cmp_eq_u32 s4, 0
  s_cbranch_scc1 Searly_80
  v_mov_b64 v[64:65], 0
  ds_read_b128 v[88:91], v9 offset:0
  ds_read_b128 v[92:95], v9 offset:1024
  v_mov_b64 v[66:67], 0
  ds_read_b128 v[96:99], v9 offset:2048
  ds_read_b128 v[100:103], v9 offset:3072
  v_mov_b64 v[68:69], 0
  ds_read_b128 v[104:107], v9 offset:4096
  ds_read_b128 v[108:111], v9 offset:5120
  v_mov_b64 v[70:71], 0
  ds_read_b128 v[112:115], v9 offset:6144
  ds_read_b128 v[116:119], v9 offset:7168
  v_mov_b64 v[72:73], 0
  s_mov_b32 s51, s35
  s_xor_b32 s35, s35, 0x2000
  s_xor_b32 s32, s32, 0x40000
  v_mov_b64 v[74:75], 0
  s_xor_b32 s33, s33, 0x40000
  s_xor_b32 s56, s56, 0x40000
  s_xor_b32 s57, s57, 0x40000
  v_mov_b64 v[76:77], 0
  s_xor_b32 s36, s36, 0x2000
  s_add_u32 s7, s7, 1
  s_mov_b32 m0, s38
  v_mov_b64 v[78:79], 0
  s_mov_b32 s42, 0
  v_mov_b64 v[80:81], 0
  v_mov_b64 v[82:83], 0
  v_mov_b64 v[84:85], 0
  v_mov_b64 v[86:87], 0
  v_xor_b32 v10, 0x2000, v10
  v_mov_b32 v126, -1
  s_nop 5
  s_cmp_lg_u32 s4, 1
  s_cbranch_scc1 Sidle_78
  buffer_load_dwordx4 v[48:51], v11, s[8:11], s34 offen offset:0 sc1
  buffer_load_dwordx4 v[52:55], v11, s[8:11], s34 offen offset:1024 sc1
  buffer_load_dwordx4 v[56:59], v11, s[8:11], s34 offen offset:2048 sc1
  buffer_load_dwordx4 v[60:63], v11, s[8:11], s34 offen offset:3072 sc1
  s_nop 15
  s_nop 11
  buffer_load_dwordx4 v[32:35], v11, s[8:11], s34 offen offset:0 sc1
  buffer_load_dwordx4 v[36:39], v11, s[8:11], s34 offen offset:1024 sc1
  buffer_load_dwordx4 v[40:43], v11, s[8:11], s34 offen offset:2048 sc1
  buffer_load_dwordx4 v[44:47], v11, s[8:11], s34 offen offset:3072 sc1
Slp1_75:
  s_waitcnt vmcnt(7)
  v_mfma_f32_16x16x32_bf16 v[120:123], v[20:23], v[48:51], 0
  s_waitcnt vmcnt(6)
  v_mfma_f32_16x16x32_bf16 v[120:123], v[20:23], v[52:55], v[120:123]
  v_bitop3_b32 v124, v48, v52, s50 bitop3:0x7e
  s_waitcnt vmcnt(5)
  v_mfma_f32_16x16x32_bf16 v[120:123], v[20:23], v[56:59], v[120:123]
  s_waitcnt vmcnt(4)
  v_mfma_f32_16x16x32_bf16 v[120:123], v[20:23], v[60:63], v[120:123]
  v_bitop3_b32 v125, v56, v60, s50 bitop3:0x7e
  v_bitop3_b32 v124, v124, v125, 1 bitop3:0xa8
  v_cmp_ne_u32 vcc, 0, v124
  s_nop 4
  v_add_f32_dpp v120, v120, v120 row_ror:8 row_mask:0xf bank_mask:0xf
  v_add_f32_dpp v121, v121, v121 row_ror:8 row_mask:0xf bank_mask:0xf
  v_cvt_pk_bf16_f32 v120, v120, v121
  s_cbranch_vccnz Sr1_72
Sok1_71:
  buffer_store_dword v120, v14, s[8:11], s35 offen sc1
  buffer_store_dword v126, v14, s[8:11], s51 offen sc1
Sj2_79:
  s_barrier
  s_nop 12
  buffer_load_dwordx4 v[32:35], v11, s[8:11], s36 offen sc1
  buffer_load_dwordx4 v[36:39], v11, s[8:11], s36 offen offset:1024 sc1
  v_mov_b64 v[120:121], v[24:25]
  s_xor_b32 s34, s34, 0x40000
  s_bfe_u32 s50, s7, 0x10001
  s_mov_b32 s42, 0
  v_mov_b64 v[122:123], v[26:27]
  v_mov_b64 v[124:125], v[28:29]
  v_mov_b64 v[126:127], v[30:31]
  s_nop 15
  s_nop 8
  buffer_load_dwordx4 v[24:27], v11, s[8:11], s36 offen sc1
  buffer_load_dwordx4 v[28:31], v11, s[8:11], s36 offen offset:1024 sc1
  s_add_u32 s43, s7, 1
  v_cmp_ge_u32 vcc, s43, v1
  s_cbranch_vccnz Srkv_56
Sbkv_57:
  s_add_u32 s43, s7, 4
  v_cmp_ge_u32 vcc, s43, v1
  s_or_b32 s55, vcc_lo, vcc_hi
  s_mov_b32 s42, 0
  s_waitcnt lgkmcnt(0)
  s_branch Spoll_66
Sto_62:
  s_mov_b32 s6, 0
  s_waitcnt vmcnt(0)
  ds_write_b128 v2, v[32:35]
  s_branch Ss0v_63
Searly_80:
  v_mov_b64 v[64:65], 0
  ds_read_b128 v[88:91], v9 offset:0
  ds_read_b128 v[92:95], v9 offset:1024
  v_mov_b64 v[66:67], 0
  ds_read_b128 v[96:99], v9 offset:2048
  ds_read_b128 v[100:103], v9 offset:3072
  v_mov_b64 v[68:69], 0
  ds_read_b128 v[104:107], v9 offset:4096
  ds_read_b128 v[108:111], v9 offset:5120
  v_mov_b64 v[70:71], 0
  ds_read_b128 v[112:115], v9 offset:6144
  ds_read_b128 v[116:119], v9 offset:7168
  v_mov_b64 v[72:73], 0
  s_mov_b32 s51, s35
  s_xor_b32 s35, s35, 0x2000
  s_xor_b32 s32, s32, 0x40000
  v_mov_b64 v[74:75], 0
  s_xor_b32 s33, s33, 0x40000
  s_xor_b32 s56, s56, 0x40000
  s_xor_b32 s57, s57, 0x40000
  v_mov_b64 v[76:77], 0
  buffer_load_dwordx4 v[48:51], v11, s[8:11], s34 offen offset:0 sc1
  buffer_load_dwordx4 v[52:55], v11, s[8:11], s34 offen offset:1024 sc1
  buffer_load_dwordx4 v[56:59], v11, s[8:11], s34 offen offset:2048 sc1
  buffer_load_dwordx4 v[60:63], v11, s[8:11], s34 offen offset:3072 sc1
  v_mov_b64 v[78:79], 0
  v_mov_b64 v[80:81], 0
  v_mov_b64 v[82:83], 0
  v_mov_b64 v[84:85], 0
  v_mov_b64 v[86:87], 0
  v_xor_b32 v10, 0x2000, v10
  v_mov_b32 v126, -1
  s_xor_b32 s36, s36, 0x2000
  s_add_u32 s7, s7, 1
  s_mov_b32 m0, s38
  s_mov_b32 s42, 0
  s_waitcnt vmcnt(3)
  v_mfma_f32_16x16x32_bf16 v[120:123], v[20:23], v[48:51], 0
  s_waitcnt vmcnt(2)
  v_mfma_f32_16x16x32_bf16 v[120:123], v[20:23], v[52:55], v[120:123]
  v_bitop3_b32 v124, v48, v52, s50 bitop3:0x7e
  s_waitcnt vmcnt(1)
  v_mfma_f32_16x16x32_bf16 v[120:123], v[20:23], v[56:59], v[120:123]
  s_waitcnt vmcnt(0)
  v_mfma_f32_16x16x32_bf16 v[120:123], v[20:23], v[60:63], v[120:123]
  v_bitop3_b32 v125, v56, v60, s50 bitop3:0x7e
  v_bitop3_b32 v124, v124, v125, 1 bitop3:0xa8
  v_cmp_ne_u32 vcc, 0, v124
  s_nop 4
  v_add_f32_dpp v120, v120, v120 row_ror:8 row_mask:0xf bank_mask:0xf
  v_add_f32_dpp v121, v121, v121 row_ror:8 row_mask:0xf bank_mask:0xf
  v_cvt_pk_bf16_f32 v120, v120, v121
  s_cbranch_vccz Sok1_71
  buffer_load_dwordx4 v[48:51], v11, s[8:11], s34 offen offset:0 sc1
  buffer_load_dwordx4 v[52:55], v11, s[8:11], s34 offen offset:1024 sc1
  buffer_load_dwordx4 v[56:59], v11, s[8:11], s34 offen offset:2048 sc1
  buffer_load_dwordx4 v[60:63], v11, s[8:11], s34 offen offset:3072 sc1
  s_nop 15
  s_nop 7
  buffer_load_dwordx4 v[32:35], v11, s[8:11], s34 offen offset:0 sc1
  buffer_load_dwordx4 v[36:39], v11, s[8:11], s34 offen offset:1024 sc1
  buffer_load_dwordx4 v[40:43], v11, s[8:11], s34 offen offset:2048 sc1
  buffer_load_dwordx4 v[44:47], v11, s[8:11], s34 offen offset:3072 sc1
  s_branch Slp1_75
Sidle_78:
  s_waitcnt vmcnt(0)
  s_branch Sj2_79
Sr1_72:
  buffer_load_dwordx4 v[48:51], v11, s[8:11], s34 offen offset:0 sc1
  buffer_load_dwordx4 v[52:55], v11, s[8:11], s34 offen offset:1024 sc1
  buffer_load_dwordx4 v[56:59], v11, s[8:11], s34 offen offset:2048 sc1
  buffer_load_dwordx4 v[60:63], v11, s[8:11], s34 offen offset:3072 sc1
  s_waitcnt vmcnt(7)
  v_mfma_f32_16x16x32_bf16 v[120:123], v[20:23], v[32:35], 0
  s_waitcnt vmcnt(6)
  v_mfma_f32_16x16x32_bf16 v[120:123], v[20:23], v[36:39], v[120:123]
  v_bitop3_b32 v124, v32, v36, s50 bitop3:0x7e
  s_waitcnt vmcnt(5)
  v_mfma_f32_16x16x32_bf16 v[120:123], v[20:23], v[40:43], v[120:123]
  s_waitcnt vmcnt(4)
  v_mfma_f32_16x16x32_bf16 v[120:123], v[20:23], v[44:47], v[120:123]
  v_bitop3_b32 v125, v40, v44, s50 bitop3:0x7e
  v_bitop3_b32 v124, v124, v125, 1 bitop3:0xa8
  v_cmp_ne_u32 vcc, 0, v124
  s_nop 4
  v_add_f32_dpp v120, v120, v120 row_ror:8 row_mask:0xf bank_mask:0xf
  v_add_f32_dpp v121, v121, v121 row_ror:8 row_mask:0xf bank_mask:0xf
  v_cvt_pk_bf16_f32 v120, v120, v121
  s_cbranch_vccz Sok1_71
  buffer_load_dwordx4 v[32:35], v11, s[8:11], s34 offen offset:0 sc1
  buffer_load_dwordx4 v[36:39], v11, s[8:11], s34 offen offset:1024 sc1
  buffer_load_dwordx4 v[40:43], v11, s[8:11], s34 offen offset:2048 sc1
  buffer_load_dwordx4 v[44:47], v11, s[8:11], s34 offen offset:3072 sc1
  s_add_u32 s42, s42, 1
  s_cmp_lt_u32 s42, s6
  s_cbranch_scc1 Slp1_75
  s_mov_b32 s6, 0
  s_branch Sok1_71
Srqf_69:
  buffer_load_dword v1, v0, s[8:11], s46 offen sc1
  s_branch Sbqf_70
Srkv_56:
  s_mov_b32 s42, 0
  s_add_u32 s43, s7, 1
kvr_81:
  buffer_load_dword v1, v0, s[8:11], s46 offen sc1
  s_waitcnt vmcnt(0)
  v_cmp_ge_u32 vcc, s43, v1
  s_cbranch_vccz kvok_82
  s_sleep 2
  s_add_u32 s42, s42, 1
  s_cmp_lt_u32 s42, s6
  s_cbranch_scc1 kvr_81
  s_mov_b32 s6, 0
kvok_82:
  s_branch Sbkv_57
Srsm_54:
  v_max3_f32 v64, v108, v109, v110
  v_max3_f32 v64, v111, v112, v64
  v_max3_f32 v64, v113, v114, v64
  v_max3_f32 v64, v115, v118, v64
  v_max_f32 v64, v119, v64
  v_mov_b32 v65, v64
  s_nop 1
  v_permlane32_swap_b32 v64, v65
  v_max_f32 v64, v64, v65
  v_mov_b32 v65, v64
  s_nop 1
  v_permlane16_swap_b32 v64, v65
  v_max_f32 v64, v64, v65
  v_sub_f32 v108, v108, v64
  v_sub_f32 v109, v109, v64
  v_sub_f32 v110, v110, v64
  v_sub_f32 v111, v111, v64
  v_sub_f32 v112, v112, v64
  v_sub_f32 v113, v113, v64
  v_sub_f32 v114, v114, v64
  v_sub_f32 v115, v115, v64
  v_sub_f32 v118, v118, v64
  v_sub_f32 v119, v119, v64
  v_exp_f32 v100, v108
  v_exp_f32 v101, v109
  v_exp_f32 v102, v110
  v_exp_f32 v103, v111
  v_exp_f32 v104, v112
  v_exp_f32 v105, v113
  v_exp_f32 v106, v114
  v_exp_f32 v107, v115
  v_exp_f32 v116, v118
  v_exp_f32 v117, v119
  v_cvt_pk_bf16_f32 v100, v100, v101
  v_cvt_pk_bf16_f32 v101, v102, v103
  v_cvt_pk_bf16_f32 v102, v104, v105
  v_cvt_pk_bf16_f32 v103, v106, v107
  v_cvt_pk_bf16_f32 v92, v116, v117
  v_cvt_pk_bf16_f32 v95, v116, v117
  s_nop 0
  v_mfma_f32_16x16x16_bf16 v[96:99], v[92:93], v[88:89], 0
  v_mfma_f32_16x16x16_bf16 v[80:83], v[92:93], v[18:19], 0
  v_mfma_f32_16x16x16_bf16 v[84:87], v[94:95], v[18:19], 0
  v_mfma_f32_16x16x32_bf16 v[96:99], v[100:103], v[88:91], v[96:99]
  v_mfma_f32_16x16x32_bf16 v[80:83], v[100:103], v[120:123], v[80:83]
  v_mfma_f32_16x16x32_bf16 v[84:87], v[100:103], v[124:127], v[84:87]
  s_mov_b32 s49, 0x7f800000
  v_rcp_f32 v96, v96
  v_rcp_f32 v97, v97
  s_waitcnt lgkmcnt(0)
  s_branch Sbsm_55
Sexit_52:
  buffer_store_dwordx4 v[16:19], v11, s[8:11], s39 offen sc1
  s_cmp_lt_u32 s7, 63
  s_cbranch_scc1 Sbexit_53
  s_waitcnt lgkmcnt(0)
CHdone_20:
  s_waitcnt vmcnt(0)
  s_branch END_1
SWAP_2:
  s_waitcnt vmcnt(0) lgkmcnt(0)
  s_barrier
  s_mov_b32 s101, 1
  s_mov_b32 s3, s2
  s_and_b32 s47, s2, 7
  s_cmp_eq_u32 s47, 0
  s_cselect_b32 s47, 1, 0
  s_xor_b32 s46, s47, 1
  v_mbcnt_lo_u32_b32 v1, -1, 0
  v_mbcnt_hi_u32_b32 v1, -1, v1
  s_lshl_b32 s44, s4, 6
  v_add_u32 v0, s44, v1
  s_cmp_lg_u32 s4, 0
  s_cbranch_scc1 SWo_83
  s_mov_b64 exec, 1
  s_lshl_b32 s48, s47, 2
  v_mov_b32 v2, 0
  v_mov_b32 v4, 1
  buffer_atomic_add v4, v2, s[24:27], s48 offen sc0 sc1
  s_lshl_b32 s49, s47, 4
  s_lshl_b32 s50, s46, 4
  s_add_u32 s51, s2, 1
  s_lshl_b32 s51, s51, s49
  s_waitcnt vmcnt(0)
  v_readfirstlane_b32 s48, v4
  s_cmp_ge_u32 s48, 32
  s_cbranch_scc1 SWd_85
  s_lshl_b32 s48, s48, 2
  s_add_u32 s48, s48, 64
  v_mov_b32 v4, s51
  buffer_atomic_or v4, v2, s[24:27], s48 offen sc0 sc1
  s_mov_b32 s52, 0
SWp_84:
  s_waitcnt vmcnt(0)
  v_readfirstlane_b32 s53, v4
  s_lshr_b32 s44, s53, s49
  s_and_b32 s44, s44, 0xffff
  s_cmp_eq_u32 s44, 0xffff
  s_cbranch_scc1 SWd_85
  s_lshr_b32 s53, s53, s50
  s_and_b32 s53, s53, 0xffff
  s_cmp_lg_u32 s53, 0
  s_cbranch_scc1 SWc_86
  s_cmp_gt_u32 s52, 400
  s_cbranch_scc1 SWd_85
  s_add_u32 s52, s52, 1
  buffer_load_dword v4, v2, s[24:27], s48 offen sc1
  s_cmp_le_u32 s52, 400
  s_cbranch_scc1 SWp_84
  s_waitcnt vmcnt(0)
  s_lshl_b32 s53, 0xffff, s50
  s_or_b32 s53, s53, s51
  v_mov_b32 v4, s53
  v_mov_b32 v5, s51
  buffer_atomic_cmpswap v[4:5], v2, s[24:27], s48 offen sc0 sc1
  s_branch SWp_84
SWc_86:
  s_sub_u32 s3, s53, 1
  s_and_b32 s3, s3, 255
SWd_85:
  v_mov_b32 v3, s3
  v_mov_b32 v2, 163328
  ds_write_b32 v2, v3
  s_mov_b64 exec, -1
  s_waitcnt lgkmcnt(0)
SWo_83:
  s_barrier
  v_mov_b32 v2, 163328
  ds_read_b32 v3, v2
  s_waitcnt lgkmcnt(0)
  v_readfirstlane_b32 s3, v3
  s_branch ROLED_3
WORK_4:
  s_load_dwordx2 s[16:17], s[0:1], 0
  s_load_dwordx2 s[20:21], s[0:1], 88
  s_waitcnt lgkmcnt(0)
  s_and_b32 s17, s17, 0xffff
  s_mov_b32 s18, 0x200000
  s_mov_b32 s19, 0x20000
  s_and_b32 s21, s21, 0xffff
  s_mov_b32 s22, 0x200000
  s_mov_b32 s23, 0x20000
  s_and_b32 s9, s9, 0xffff
  s_mov_b32 s10, 0x10000000
  s_mov_b32 s11, 0x20000
  s_and_b32 s25, s25, 0xffff
  s_mov_b32 s26, 0x100
  s_mov_b32 s27, 0x20000
  s_mov_b32 s100, s54
  s_lshl_b32 s44, s101, 8
  s_or_b32 s44, s44, s2
  s_and_b32 s40, s44, 0xfffffff7
  s_cmp_lg_u32 s40, 7
  s_cbranch_scc1 Z_87
  v_mov_b32 v4, 0
  v_mov_b32 v5, 0
  v_mov_b32 v6, 0
  v_mov_b32 v7, 0
  s_cmp_eq_u32 s44, 7
  s_cselect_b32 s41, 4, 7
  s_cselect_b32 s40, 0, 0x6000
  s_add_u32 s40, s40, 0x7200000
  v_lshlrev_b32 v8, s41, v0
  s_lshl_b32 s42, 256, s41
  buffer_store_dwordx4 v[4:7], v8, s[8:11], s40 offen sc1
  s_add_u32 s40, s40, s42
  buffer_store_dwordx4 v[4:7], v8, s[8:11], s40 offen sc1
  s_add_u32 s40, s40, s42
  buffer_store_dwordx4 v[4:7], v8, s[8:11], s40 offen sc1
  s_add_u32 s40, s40, s42
  s_and_b32 s40, s44, 8
  v_mov_b32 v9, 1
  s_waitcnt vmcnt(0)
  s_barrier
  s_mov_b64 exec, 1
  buffer_store_dword v9, v4, s[24:27], s40 offen offset:224 sc1
  s_mov_b64 exec, -1
Z_87:
  s_cmp_ge_u32 s5, 256
  s_cbranch_scc1 END_1
  s_lshr_b32 s54, s5, 5
  s_and_b32 s55, s5, 31
  s_cmp_ge_u32 s54, 2
  s_cbranch_scc1 DOQKV_88
  s_lshl_b32 s56, s55, 2
  s_add_u32 s56, s56, 0x7200000
  v_lshrrev_b32 v2, 4, v1
  v_and_b32 v3, 15, v1
  s_lshl_b32 s40, s4, 2
  v_add_u32 v2, s40, v2
  v_lshlrev_b32 v4, 10, v2
  v_lshl_add_u32 v4, v3, 4, v4
  s_lshl_b32 s41, s55, 14
  s_add_u32 s43, s41, 0
  buffer_load_dwordx4 v[64:67], v4, s[16:19], s43 offen offset:0
  buffer_load_dwordx4 v[68:71], v4, s[16:19], s43 offen offset:256
  buffer_load_dwordx4 v[72:75], v4, s[16:19], s43 offen offset:512
  buffer_load_dwordx4 v[76:79], v4, s[16:19], s43 offen offset:768
  s_add_u32 s43, s41, 524288
  buffer_load_dwordx4 v[80:83], v4, s[16:19], s43 offen offset:0
  buffer_load_dwordx4 v[84:87], v4, s[16:19], s43 offen offset:256
  buffer_load_dwordx4 v[88:91], v4, s[16:19], s43 offen offset:512
  buffer_load_dwordx4 v[92:95], v4, s[16:19], s43 offen offset:768
  s_add_u32 s43, s41, 1048576
  buffer_load_dwordx4 v[96:99], v4, s[16:19], s43 offen offset:0
  buffer_load_dwordx4 v[100:103], v4, s[16:19], s43 offen offset:256
  buffer_load_dwordx4 v[104:107], v4, s[16:19], s43 offen offset:512
  buffer_load_dwordx4 v[108:111], v4, s[16:19], s43 offen offset:768
  s_add_u32 s43, s41, 1572864
  buffer_load_dwordx4 v[112:115], v4, s[16:19], s43 offen offset:0
  buffer_load_dwordx4 v[116:119], v4, s[16:19], s43 offen offset:256
  buffer_load_dwordx4 v[120:123], v4, s[16:19], s43 offen offset:512
  buffer_load_dwordx4 v[124:127], v4, s[16:19], s43 offen offset:768
  v_lshrrev_b32 v5, 2, v3
  v_lshlrev_b32 v5, 10, v5
  v_and_b32 v6, 3, v3
  v_lshl_add_u32 v5, v6, 8, v5
  v_lshl_add_u32 v5, v2, 4, v5
  s_waitcnt vmcnt(12)
  v_mov_b32 v15, 0
  buffer_load_dwordx2 a[254:255], v15, s[24:27], 0 offen offset:224 sc1
  s_mov_b32 s43, 0
LN1l_90:
  v_lshlrev_b32 v32, 16, v64
  v_and_b32 v33, 0xffff0000, v64
  v_lshlrev_b32 v34, 16, v65
  v_and_b32 v35, 0xffff0000, v65
  v_lshlrev_b32 v36, 16, v66
  v_and_b32 v37, 0xffff0000, v66
  v_lshlrev_b32 v38, 16, v67
  v_and_b32 v39, 0xffff0000, v67
  v_lshlrev_b32 v40, 16, v68
  v_and_b32 v41, 0xffff0000, v68
  v_lshlrev_b32 v42, 16, v69
  v_and_b32 v43, 0xffff0000, v69
  v_lshlrev_b32 v44, 16, v70
  v_and_b32 v45, 0xffff0000, v70
  v_lshlrev_b32 v46, 16, v71
  v_and_b32 v47, 0xffff0000, v71
  v_lshlrev_b32 v48, 16, v72
  v_and_b32 v49, 0xffff0000, v72
  v_lshlrev_b32 v50, 16, v73
  v_and_b32 v51, 0xffff0000, v73
  v_lshlrev_b32 v52, 16, v74
  v_and_b32 v53, 0xffff0000, v74
  v_lshlrev_b32 v54, 16, v75
  v_and_b32 v55, 0xffff0000, v75
  v_lshlrev_b32 v56, 16, v76
  v_and_b32 v57, 0xffff0000, v76
  v_lshlrev_b32 v58, 16, v77
  v_and_b32 v59, 0xffff0000, v77
  v_lshlrev_b32 v60, 16, v78
  v_and_b32 v61, 0xffff0000, v78
  v_lshlrev_b32 v62, 16, v79
  v_and_b32 v63, 0xffff0000, v79
  v_add_f32 v24, v32, v33
  v_add_f32 v25, v34, v35
  v_add_f32 v24, v24, v36
  v_add_f32 v25, v25, v37
  v_add_f32 v24, v24, v38
  v_add_f32 v25, v25, v39
  v_add_f32 v24, v24, v40
  v_add_f32 v25, v25, v41
  v_add_f32 v24, v24, v42
  v_add_f32 v25, v25, v43
  v_add_f32 v24, v24, v44
  v_add_f32 v25, v25, v45
  v_add_f32 v24, v24, v46
  v_add_f32 v25, v25, v47
  v_add_f32 v24, v24, v48
  v_add_f32 v25, v25, v49
  v_add_f32 v24, v24, v50
  v_add_f32 v25, v25, v51
  v_add_f32 v24, v24, v52
  v_add_f32 v25, v25, v53
  v_add_f32 v24, v24, v54
  v_add_f32 v25, v25, v55
  v_add_f32 v24, v24, v56
  v_add_f32 v25, v25, v57
  v_add_f32 v24, v24, v58
  v_add_f32 v25, v25, v59
  v_add_f32 v24, v24, v60
  v_add_f32 v25, v25, v61
  v_add_f32 v24, v24, v62
  v_add_f32 v25, v25, v63
  v_add_f32 v24, v24, v25
  s_nop 1
  v_add_f32_dpp v24, v24, v24 row_ror:1 row_mask:0xf bank_mask:0xf
  s_nop 1
  v_add_f32_dpp v24, v24, v24 row_ror:2 row_mask:0xf bank_mask:0xf
  s_nop 1
  v_add_f32_dpp v24, v24, v24 row_ror:4 row_mask:0xf bank_mask:0xf
  s_nop 1
  v_add_f32_dpp v24, v24, v24 row_ror:8 row_mask:0xf bank_mask:0xf
  v_mul_f32 v24, 0x3b000000, v24
  v_mov_b32 v25, 0
  v_mov_b32 v26, 0
  v_sub_f32 v27, v32, v24
  v_sub_f32 v28, v33, v24
  v_fmac_f32 v25, v27, v27
  v_fmac_f32 v26, v28, v28
  v_sub_f32 v27, v34, v24
  v_sub_f32 v28, v35, v24
  v_fmac_f32 v25, v27, v27
  v_fmac_f32 v26, v28, v28
  v_sub_f32 v27, v36, v24
  v_sub_f32 v28, v37, v24
  v_fmac_f32 v25, v27, v27
  v_fmac_f32 v26, v28, v28
  v_sub_f32 v27, v38, v24
  v_sub_f32 v28, v39, v24
  v_fmac_f32 v25, v27, v27
  v_fmac_f32 v26, v28, v28
  v_sub_f32 v27, v40, v24
  v_sub_f32 v28, v41, v24
  v_fmac_f32 v25, v27, v27
  v_fmac_f32 v26, v28, v28
  v_sub_f32 v27, v42, v24
  v_sub_f32 v28, v43, v24
  v_fmac_f32 v25, v27, v27
  v_fmac_f32 v26, v28, v28
  v_sub_f32 v27, v44, v24
  v_sub_f32 v28, v45, v24
  v_fmac_f32 v25, v27, v27
  v_fmac_f32 v26, v28, v28
  v_sub_f32 v27, v46, v24
  v_sub_f32 v28, v47, v24
  v_fmac_f32 v25, v27, v27
  v_fmac_f32 v26, v28, v28
  v_sub_f32 v27, v48, v24
  v_sub_f32 v28, v49, v24
  v_fmac_f32 v25, v27, v27
  v_fmac_f32 v26, v28, v28
  v_sub_f32 v27, v50, v24
  v_sub_f32 v28, v51, v24
  v_fmac_f32 v25, v27, v27
  v_fmac_f32 v26, v28, v28
  v_sub_f32 v27, v52, v24
  v_sub_f32 v28, v53, v24
  v_fmac_f32 v25, v27, v27
  v_fmac_f32 v26, v28, v28
  v_sub_f32 v27, v54, v24
  v_sub_f32 v28, v55, v24
  v_fmac_f32 v25, v27, v27
  v_fmac_f32 v26, v28, v28
  v_sub_f32 v27, v56, v24
  v_sub_f32 v28, v57, v24
  v_fmac_f32 v25, v27, v27
  v_fmac_f32 v26, v28, v28
  v_sub_f32 v27, v58, v24
  v_sub_f32 v28, v59, v24
  v_fmac_f32 v25, v27, v27
  v_fmac_f32 v26, v28, v28
  v_sub_f32 v27, v60, v24
  v_sub_f32 v28, v61, v24
  v_fmac_f32 v25, v27, v27
  v_fmac_f32 v26, v28, v28
  v_sub_f32 v27, v62, v24
  v_sub_f32 v28, v63, v24
  v_fmac_f32 v25, v27, v27
  v_fmac_f32 v26, v28, v28
  v_add_f32 v25, v25, v26
  s_nop 1
  v_add_f32_dpp v25, v25, v25 row_ror:1 row_mask:0xf bank_mask:0xf
  s_nop 1
  v_add_f32_dpp v25, v25, v25 row_ror:2 row_mask:0xf bank_mask:0xf
  s_nop 1
  v_add_f32_dpp v25, v25, v25 row_ror:4 row_mask:0xf bank_mask:0xf
  s_nop 1
  v_add_f32_dpp v25, v25, v25 row_ror:8 row_mask:0xf bank_mask:0xf
  v_mul_f32 v25, 0x3b000000, v25
  v_cvt_pk_bf16_f32 v24, v24, v24
  v_lshlrev_b32 v24, 16, v24
  v_cvt_pk_bf16_f32 v25, v25, v25
  v_lshlrev_b32 v25, 16, v25
  v_add_f32 v25, 0x3727c5ac, v25
  v_cvt_pk_bf16_f32 v25, v25, v25
  v_lshlrev_b32 v25, 16, v25
  v_sqrt_f32 v25, v25
  s_nop 0
  v_cvt_pk_bf16_f32 v25, v25, v25
  v_lshlrev_b32 v25, 16, v25
  v_rcp_f32 v25, v25
  v_sub_f32 v32, v32, v24
  v_sub_f32 v33, v33, v24
  v_cvt_pk_bf16_f32 v26, v32, v33
  v_lshlrev_b32 v32, 16, v26
  v_and_b32 v33, 0xffff0000, v26
  v_mul_f32 v32, v32, v25
  v_mul_f32 v33, v33, v25
  v_cvt_pk_bf16_f32 v8, v32, v33
  v_sub_f32 v34, v34, v24
  v_sub_f32 v35, v35, v24
  v_cvt_pk_bf16_f32 v26, v34, v35
  v_lshlrev_b32 v34, 16, v26
  v_and_b32 v35, 0xffff0000, v26
  v_mul_f32 v34, v34, v25
  v_mul_f32 v35, v35, v25
  v_cvt_pk_bf16_f32 v9, v34, v35
  v_sub_f32 v36, v36, v24
  v_sub_f32 v37, v37, v24
  v_cvt_pk_bf16_f32 v26, v36, v37
  v_lshlrev_b32 v36, 16, v26
  v_and_b32 v37, 0xffff0000, v26
  v_mul_f32 v36, v36, v25
  v_mul_f32 v37, v37, v25
  v_cvt_pk_bf16_f32 v10, v36, v37
  v_sub_f32 v38, v38, v24
  v_sub_f32 v39, v39, v24
  v_cvt_pk_bf16_f32 v26, v38, v39
  v_lshlrev_b32 v38, 16, v26
  v_and_b32 v39, 0xffff0000, v26
  v_mul_f32 v38, v38, v25
  v_mul_f32 v39, v39, v25
  v_cvt_pk_bf16_f32 v11, v38, v39
  v_sub_f32 v40, v40, v24
  v_sub_f32 v41, v41, v24
  v_cvt_pk_bf16_f32 v26, v40, v41
  v_lshlrev_b32 v40, 16, v26
  v_and_b32 v41, 0xffff0000, v26
  v_mul_f32 v40, v40, v25
  v_mul_f32 v41, v41, v25
  v_cvt_pk_bf16_f32 v12, v40, v41
  v_sub_f32 v42, v42, v24
  v_sub_f32 v43, v43, v24
  v_cvt_pk_bf16_f32 v26, v42, v43
  v_lshlrev_b32 v42, 16, v26
  v_and_b32 v43, 0xffff0000, v26
  v_mul_f32 v42, v42, v25
  v_mul_f32 v43, v43, v25
  v_cvt_pk_bf16_f32 v13, v42, v43
  v_sub_f32 v44, v44, v24
  v_sub_f32 v45, v45, v24
  v_cvt_pk_bf16_f32 v26, v44, v45
  v_lshlrev_b32 v44, 16, v26
  v_and_b32 v45, 0xffff0000, v26
  v_mul_f32 v44, v44, v25
  v_mul_f32 v45, v45, v25
  v_cvt_pk_bf16_f32 v14, v44, v45
  v_sub_f32 v46, v46, v24
  v_sub_f32 v47, v47, v24
  v_cvt_pk_bf16_f32 v26, v46, v47
  v_lshlrev_b32 v46, 16, v26
  v_and_b32 v47, 0xffff0000, v26
  v_mul_f32 v46, v46, v25
  v_mul_f32 v47, v47, v25
  v_cvt_pk_bf16_f32 v15, v46, v47
  v_sub_f32 v48, v48, v24
  v_sub_f32 v49, v49, v24
  v_cvt_pk_bf16_f32 v26, v48, v49
  v_lshlrev_b32 v48, 16, v26
  v_and_b32 v49, 0xffff0000, v26
  v_mul_f32 v48, v48, v25
  v_mul_f32 v49, v49, v25
  v_cvt_pk_bf16_f32 v16, v48, v49
  v_sub_f32 v50, v50, v24
  v_sub_f32 v51, v51, v24
  v_cvt_pk_bf16_f32 v26, v50, v51
  v_lshlrev_b32 v50, 16, v26
  v_and_b32 v51, 0xffff0000, v26
  v_mul_f32 v50, v50, v25
  v_mul_f32 v51, v51, v25
  v_cvt_pk_bf16_f32 v17, v50, v51
  v_sub_f32 v52, v52, v24
  v_sub_f32 v53, v53, v24
  v_cvt_pk_bf16_f32 v26, v52, v53
  v_lshlrev_b32 v52, 16, v26
  v_and_b32 v53, 0xffff0000, v26
  v_mul_f32 v52, v52, v25
  v_mul_f32 v53, v53, v25
  v_cvt_pk_bf16_f32 v18, v52, v53
  v_sub_f32 v54, v54, v24
  v_sub_f32 v55, v55, v24
  v_cvt_pk_bf16_f32 v26, v54, v55
  v_lshlrev_b32 v54, 16, v26
  v_and_b32 v55, 0xffff0000, v26
  v_mul_f32 v54, v54, v25
  v_mul_f32 v55, v55, v25
  v_cvt_pk_bf16_f32 v19, v54, v55
  v_sub_f32 v56, v56, v24
  v_sub_f32 v57, v57, v24
  v_cvt_pk_bf16_f32 v26, v56, v57
  v_lshlrev_b32 v56, 16, v26
  v_and_b32 v57, 0xffff0000, v26
  v_mul_f32 v56, v56, v25
  v_mul_f32 v57, v57, v25
  v_cvt_pk_bf16_f32 v20, v56, v57
  v_sub_f32 v58, v58, v24
  v_sub_f32 v59, v59, v24
  v_cvt_pk_bf16_f32 v26, v58, v59
  v_lshlrev_b32 v58, 16, v26
  v_and_b32 v59, 0xffff0000, v26
  v_mul_f32 v58, v58, v25
  v_mul_f32 v59, v59, v25
  v_cvt_pk_bf16_f32 v21, v58, v59
  v_sub_f32 v60, v60, v24
  v_sub_f32 v61, v61, v24
  v_cvt_pk_bf16_f32 v26, v60, v61
  v_lshlrev_b32 v60, 16, v26
  v_and_b32 v61, 0xffff0000, v26
  v_mul_f32 v60, v60, v25
  v_mul_f32 v61, v61, v25
  v_cvt_pk_bf16_f32 v22, v60, v61
  v_sub_f32 v62, v62, v24
  v_sub_f32 v63, v63, v24
  v_cvt_pk_bf16_f32 v26, v62, v63
  v_lshlrev_b32 v62, 16, v26
  v_and_b32 v63, 0xffff0000, v26
  v_mul_f32 v62, v62, v25
  v_mul_f32 v63, v63, v25
  v_cvt_pk_bf16_f32 v23, v62, v63
  s_add_u32 s42, s41, 0x0
  buffer_store_dwordx4 v[8:11], v5, s[8:11], s42 offen sc1
  s_add_u32 s42, s41, 0x1000
  buffer_store_dwordx4 v[12:15], v5, s[8:11], s42 offen sc1
  s_add_u32 s42, s41, 0x2000
  buffer_store_dwordx4 v[16:19], v5, s[8:11], s42 offen sc1
  s_add_u32 s42, s41, 0x3000
  buffer_store_dwordx4 v[20:23], v5, s[8:11], s42 offen sc1
  s_add_u32 s43, s43, 1
  s_cmp_lg_u32 s43, 1
  s_cbranch_scc1 LNs_91
  s_waitcnt vmcnt(0)
  v_accvgpr_read_b32 v2, a254
  v_accvgpr_read_b32 v3, a255
  v_readfirstlane_b32 s44, v2
  v_readfirstlane_b32 s42, v3
  s_cmp_eq_u32 s44, 0
  s_cbranch_scc1 TRs_93
  s_cmp_eq_u32 s42, 0
  s_cbranch_scc1 TRs_93
  s_cmp_lg_u32 s42, s100
  s_cbranch_scc1 TRf_92
TRs_93:
  s_cmp_lg_u32 s101, 0
  s_cbranch_scc1 NT_94
  s_mov_b32 s42, 0
  v_mov_b32 v3, 0
rdy_96:
  buffer_load_dword v2, v3, s[24:27], 0 offen offset:228 sc1
  s_waitcnt vmcnt(0)
  v_cmp_eq_u32 vcc, 0, v2
  s_cbranch_vccz rdyok_97
  s_sleep 1
  s_add_u32 s42, s42, 1
  s_cmp_lt_u32 s42, s6
  s_cbranch_scc1 rdy_96
  s_mov_b32 s6, 0
rdyok_97:
  v_readfirstlane_b32 s44, v2
  s_cmp_lg_u32 s44, s100
  s_cbranch_scc1 NT_94
  s_mov_b32 s54, s100
  s_branch SWAP_2
NT_94:
  s_mov_b32 s42, 0
  v_mov_b32 v3, 0
rdy_98:
  buffer_load_dword v2, v3, s[24:27], 0 offen offset:224 sc1
  s_waitcnt vmcnt(0)
  v_cmp_eq_u32 vcc, 0, v2
  s_cbranch_vccz rdyok_99
  s_sleep 1
  s_add_u32 s42, s42, 1
  s_cmp_lt_u32 s42, s6
  s_cbranch_scc1 rdy_98
  s_mov_b32 s6, 0
rdyok_99:
TRf_92:
  s_waitcnt vmcnt(0)
  s_barrier
  s_cmp_lg_u32 s4, 0
  s_cbranch_scc1 sf_100
  v_mov_b32 v2, 1
  v_mov_b32 v3, 0
  s_mov_b64 exec, 1
  buffer_store_dword v2, v3, s[8:11], s56 offen sc1
  s_mov_b64 exec, -1
sf_100:
LNs_91:
  v_mov_b64 v[64:65], v[80:81]
  v_mov_b64 v[66:67], v[82:83]
  v_mov_b64 v[68:69], v[84:85]
  v_mov_b64 v[70:71], v[86:87]
  v_mov_b64 v[72:73], v[88:89]
  v_mov_b64 v[74:75], v[90:91]
  v_mov_b64 v[76:77], v[92:93]
  v_mov_b64 v[78:79], v[94:95]
  v_mov_b64 v[80:81], v[96:97]
  v_mov_b64 v[82:83], v[98:99]
  v_mov_b64 v[84:85], v[100:101]
  v_mov_b64 v[86:87], v[102:103]
  v_mov_b64 v[88:89], v[104:105]
  v_mov_b64 v[90:91], v[106:107]
  v_mov_b64 v[92:93], v[108:109]
  v_mov_b64 v[94:95], v[110:111]
  v_mov_b64 v[96:97], v[112:113]
  v_mov_b64 v[98:99], v[114:115]
  v_mov_b64 v[100:101], v[116:117]
  v_mov_b64 v[102:103], v[118:119]
  v_mov_b64 v[104:105], v[120:121]
  v_mov_b64 v[106:107], v[122:123]
  v_mov_b64 v[108:109], v[124:125]
  v_mov_b64 v[110:111], v[126:127]
  s_add_u32 s41, s41, 524288
  s_cmp_lt_u32 s43, 4
  s_cbranch_scc1 LN1l_90
  s_waitcnt vmcnt(0)
  s_barrier
  s_cmp_lg_u32 s4, 0
  s_cbranch_scc1 sf_101
  v_mov_b32 v2, 4
  v_mov_b32 v3, 0
  s_mov_b64 exec, 1
  buffer_store_dword v2, v3, s[8:11], s56 offen sc1
  s_mov_b64 exec, -1
sf_101:
  s_branch ROLE2_89
DOQKV_88:
  s_sub_u32 s58, s5, 64
  s_lshr_b32 s32, s58, 6
  s_bfe_u32 s33, s58, 0x50001
  s_and_b32 s34, s58, 1
  s_lshl_b32 s35, s32, 3
  s_add_u32 s35, s35, 24
  s_cmp_eq_u32 s32, 2
  s_cselect_b32 s35, 16, s35
  s_load_dwordx2 s[12:13], s[0:1], s35
  s_lshl_b32 s36, s33, 8
  s_waitcnt lgkmcnt(0)
  s_and_b32 s13, s13, 0xffff
  s_mov_b32 s14, 0x400000
  s_mov_b32 s15, 0x20000
  v_lshrrev_b32 v9, 4, v1
  v_lshlrev_b32 v8, 2, v9
  v_xor_b32 v8, v8, v1
  v_and_b32 v8, 15, v8
  v_lshlrev_b32 v8, 4, v8
  s_mov_b32 s44, 8192
  v_mad_u32_u24 v8, v9, s44, v8
  s_mul_i32 s44, s4, 32768
  s_add_u32 s44, s44, s36
  s_lshl_b32 s45, s4, 10
  s_mov_b32 m0, s45
  s_nop 0
  buffer_load_dwordx4 v8, s[12:15], s44 offen lds
  s_add_u32 s44, s44, 131072
  s_add_u32 s45, s45, 4096
  s_mov_b32 m0, s45
  s_nop 0
  buffer_load_dwordx4 v8, s[12:15], s44 offen lds
  s_add_u32 s44, s44, 131072
  s_add_u32 s45, s45, 4096
  s_mov_b32 m0, s45
  s_nop 0
  buffer_load_dwordx4 v8, s[12:15], s44 offen lds
  s_add_u32 s44, s44, 131072
  s_add_u32 s45, s45, 4096
  s_mov_b32 m0, s45
  s_nop 0
  buffer_load_dwordx4 v8, s[12:15], s44 offen lds
  s_add_u32 s44, s44, 131072
  s_add_u32 s45, s45, 4096
  s_mov_b32 m0, s45
  s_nop 0
  buffer_load_dwordx4 v8, s[12:15], s44 offen lds
  s_add_u32 s44, s44, 131072
  s_add_u32 s45, s45, 4096
  s_mov_b32 m0, s45
  s_nop 0
  buffer_load_dwordx4 v8, s[12:15], s44 offen lds
  s_add_u32 s44, s44, 131072
  s_add_u32 s45, s45, 4096
  s_mov_b32 m0, s45
  s_nop 0
  buffer_load_dwordx4 v8, s[12:15], s44 offen lds
  s_add_u32 s44, s44, 131072
  s_add_u32 s45, s45, 4096
  s_mov_b32 m0, s45
  s_nop 0
  buffer_load_dwordx4 v8, s[12:15], s44 offen lds
  s_add_u32 s44, s44, 131072
  s_add_u32 s45, s45, 4096
  s_mov_b32 m0, s45
  s_nop 0
  buffer_load_dwordx4 v8, s[12:15], s44 offen lds
  s_add_u32 s44, s44, 131072
  s_add_u32 s45, s45, 4096
  s_mov_b32 m0, s45
  s_nop 0
  buffer_load_dwordx4 v8, s[12:15], s44 offen lds
  s_add_u32 s44, s44, 131072
  s_add_u32 s45, s45, 4096
  s_mov_b32 m0, s45
  s_nop 0
  buffer_load_dwordx4 v8, s[12:15], s44 offen lds
  s_add_u32 s44, s44, 131072
  s_add_u32 s45, s45, 4096
  s_mov_b32 m0, s45
  s_nop 0
  buffer_load_dwordx4 v8, s[12:15], s44 offen lds
  s_add_u32 s44, s44, 131072
  s_add_u32 s45, s45, 4096
  s_mov_b32 m0, s45
  s_nop 0
  buffer_load_dwordx4 v8, s[12:15], s44 offen lds
  s_add_u32 s44, s44, 131072
  s_add_u32 s45, s45, 4096
  s_mov_b32 m0, s45
  s_nop 0
  buffer_load_dwordx4 v8, s[12:15], s44 offen lds
  s_add_u32 s44, s44, 131072
  s_add_u32 s45, s45, 4096
  s_mov_b32 m0, s45
  s_nop 0
  buffer_load_dwordx4 v8, s[12:15], s44 offen lds
  s_add_u32 s44, s44, 131072
  s_add_u32 s45, s45, 4096
  s_mov_b32 m0, s45
  s_nop 0
  buffer_load_dwordx4 v8, s[12:15], s44 offen lds
  s_add_u32 s44, s44, 131072
  s_add_u32 s45, s45, 4096
  s_mov_b32 m0, s45
  s_nop 0
  buffer_load_dwordx4 v8, s[12:15], s44 offen lds
  s_add_u32 s44, s44, 131072
  s_add_u32 s45, s45, 4096
  s_mov_b32 m0, s45
  s_nop 0
  buffer_load_dwordx4 v8, s[12:15], s44 offen lds
  s_add_u32 s44, s44, 131072
  s_add_u32 s45, s45, 4096
  s_mov_b32 m0, s45
  s_nop 0
  buffer_load_dwordx4 v8, s[12:15], s44 offen lds
  s_add_u32 s44, s44, 131072
  s_add_u32 s45, s45, 4096
  s_mov_b32 m0, s45
  s_nop 0
  buffer_load_dwordx4 v8, s[12:15], s44 offen lds
  s_add_u32 s44, s44, 131072
  s_add_u32 s45, s45, 4096
  s_mov_b32 m0, s45
  s_nop 0
  buffer_load_dwordx4 v8, s[12:15], s44 offen lds
  s_add_u32 s44, s44, 131072
  s_add_u32 s45, s45, 4096
  s_mov_b32 m0, s45
  s_nop 0
  buffer_load_dwordx4 v8, s[12:15], s44 offen lds
  s_add_u32 s44, s44, 131072
  s_add_u32 s45, s45, 4096
  s_mov_b32 m0, s45
  s_nop 0
  buffer_load_dwordx4 v8, s[12:15], s44 offen lds
  s_add_u32 s44, s44, 131072
  s_add_u32 s45, s45, 4096
  s_mov_b32 m0, s45
  s_nop 0
  buffer_load_dwordx4 v8, s[12:15], s44 offen lds
  s_add_u32 s44, s44, 131072
  s_add_u32 s45, s45, 4096
  s_mov_b32 m0, s45
  s_nop 0
  buffer_load_dwordx4 v8, s[12:15], s44 offen lds
  s_add_u32 s44, s44, 131072
  s_add_u32 s45, s45, 4096
  s_mov_b32 m0, s45
  s_nop 0
  buffer_load_dwordx4 v8, s[12:15], s44 offen lds
  s_add_u32 s44, s44, 131072
  s_add_u32 s45, s45, 4096
  s_mov_b32 m0, s45
  s_nop 0
  buffer_load_dwordx4 v8, s[12:15], s44 offen lds
  s_add_u32 s44, s44, 131072
  s_add_u32 s45, s45, 4096
  s_mov_b32 m0, s45
  s_nop 0
  buffer_load_dwordx4 v8, s[12:15], s44 offen lds
  s_add_u32 s44, s44, 131072
  s_add_u32 s45, s45, 4096
  s_mov_b32 m0, s45
  s_nop 0
  buffer_load_dwordx4 v8, s[12:15], s44 offen lds
  s_add_u32 s44, s44, 131072
  s_add_u32 s45, s45, 4096
  s_mov_b32 m0, s45
  s_nop 0
  buffer_load_dwordx4 v8, s[12:15], s44 offen lds
  s_add_u32 s44, s44, 131072
  s_add_u32 s45, s45, 4096
  s_mov_b32 m0, s45
  s_nop 0
  buffer_load_dwordx4 v8, s[12:15], s44 offen lds
  s_add_u32 s44, s44, 131072
  s_add_u32 s45, s45, 4096
  s_mov_b32 m0, s45
  s_nop 0
  buffer_load_dwordx4 v8, s[12:15], s44 offen lds
  v_mov_b32 v15, 0
  buffer_load_dwordx2 a[254:255], v15, s[24:27], 0 offen offset:224 sc1
  v_lshrrev_b32 v10, 4, v1
  v_lshlrev_b32 v10, 3, v10
  v_bfe_u32 v12, v1, 2, 2
  v_add_u32 v10, v10, v12
  v_lshlrev_b32 v10, 8, v10
  v_xor_b32 v12, s4, v12
  v_lshl_add_u32 v10, v12, 6, v10
  v_and_b32 v12, 3, v1
  v_lshl_add_u32 v10, v12, 4, v10
  v_add_u32 v11, 0x10000, v10
  s_waitcnt vmcnt(0)
  s_barrier
  ds_read_b64_tr_b16 v[128:129], v10 offset:0
  ds_read_b64_tr_b16 v[130:131], v10 offset:1024
  ds_read_b64_tr_b16 v[192:193], v10 offset:8
  ds_read_b64_tr_b16 v[194:195], v10 offset:1032
  ds_read_b64_tr_b16 v[132:133], v10 offset:8192
  ds_read_b64_tr_b16 v[134:135], v10 offset:9216
  ds_read_b64_tr_b16 v[196:197], v10 offset:8200
  ds_read_b64_tr_b16 v[198:199], v10 offset:9224
  ds_read_b64_tr_b16 v[136:137], v10 offset:16384
  ds_read_b64_tr_b16 v[138:139], v10 offset:17408
  ds_read_b64_tr_b16 v[200:201], v10 offset:16392
  ds_read_b64_tr_b16 v[202:203], v10 offset:17416
  s_waitcnt lgkmcnt(4)
  ds_read_b64_tr_b16 v[140:141], v10 offset:24576
  ds_read_b64_tr_b16 v[142:143], v10 offset:25600
  ds_read_b64_tr_b16 v[204:205], v10 offset:24584
  ds_read_b64_tr_b16 v[206:207], v10 offset:25608
  ds_read_b64_tr_b16 v[144:145], v10 offset:32768
  ds_read_b64_tr_b16 v[146:147], v10 offset:33792
  ds_read_b64_tr_b16 v[208:209], v10 offset:32776
  ds_read_b64_tr_b16 v[210:211], v10 offset:33800
  ds_read_b64_tr_b16 v[148:149], v10 offset:40960
  ds_read_b64_tr_b16 v[150:151], v10 offset:41984
  ds_read_b64_tr_b16 v[212:213], v10 offset:40968
  ds_read_b64_tr_b16 v[214:215], v10 offset:41992
  s_waitcnt lgkmcnt(4)
  ds_read_b64_tr_b16 v[152:153], v10 offset:49152
  ds_read_b64_tr_b16 v[154:155], v10 offset:50176
  ds_read_b64_tr_b16 v[216:217], v10 offset:49160
  ds_read_b64_tr_b16 v[218:219], v10 offset:50184
  ds_read_b64_tr_b16 v[156:157], v10 offset:57344
  ds_read_b64_tr_b16 v[158:159], v10 offset:58368
  ds_read_b64_tr_b16 v[220:221], v10 offset:57352
  ds_read_b64_tr_b16 v[222:223], v10 offset:58376
  ds_read_b64_tr_b16 v[160:161], v11 offset:0
  ds_read_b64_tr_b16 v[162:163], v11 offset:1024
  ds_read_b64_tr_b16 v[224:225], v11 offset:8
  ds_read_b64_tr_b16 v[226:227], v11 offset:1032
  s_waitcnt lgkmcnt(4)
  ds_read_b64_tr_b16 v[164:165], v11 offset:8192
  ds_read_b64_tr_b16 v[166:167], v11 offset:9216
  ds_read_b64_tr_b16 v[228:229], v11 offset:8200
  ds_read_b64_tr_b16 v[230:231], v11 offset:9224
  ds_read_b64_tr_b16 v[168:169], v11 offset:16384
  ds_read_b64_tr_b16 v[170:171], v11 offset:17408
  ds_read_b64_tr_b16 v[232:233], v11 offset:16392
  ds_read_b64_tr_b16 v[234:235], v11 offset:17416
  ds_read_b64_tr_b16 v[172:173], v11 offset:24576
  ds_read_b64_tr_b16 v[174:175], v11 offset:25600
  ds_read_b64_tr_b16 v[236:237], v11 offset:24584
  ds_read_b64_tr_b16 v[238:239], v11 offset:25608
  s_waitcnt lgkmcnt(4)
  ds_read_b64_tr_b16 v[176:177], v11 offset:32768
  ds_read_b64_tr_b16 v[178:179], v11 offset:33792
  ds_read_b64_tr_b16 v[240:241], v11 offset:32776
  ds_read_b64_tr_b16 v[242:243], v11 offset:33800
  ds_read_b64_tr_b16 v[180:181], v11 offset:40960
  ds_read_b64_tr_b16 v[182:183], v11 offset:41984
  ds_read_b64_tr_b16 v[244:245], v11 offset:40968
  ds_read_b64_tr_b16 v[246:247], v11 offset:41992
  ds_read_b64_tr_b16 v[184:185], v11 offset:49152
  ds_read_b64_tr_b16 v[186:187], v11 offset:50176
  ds_read_b64_tr_b16 v[248:249], v11 offset:49160
  ds_read_b64_tr_b16 v[250:251], v11 offset:50184
  s_waitcnt lgkmcnt(4)
  ds_read_b64_tr_b16 v[188:189], v11 offset:57344
  ds_read_b64_tr_b16 v[190:191], v11 offset:58368
  ds_read_b64_tr_b16 v[252:253], v11 offset:57352
  ds_read_b64_tr_b16 v[254:255], v11 offset:58376
  s_waitcnt lgkmcnt(0)
  s_barrier
  s_lshl_b32 s37, s32, 24
  s_add_u32 s37, s37, 0x1200000
  s_cmp_eq_u32 s32, 2
  s_cselect_b32 s37, 0x200000, s37
  s_lshl_b32 s38, s33, 13
  s_add_u32 s37, s37, s38
  s_lshl_b32 s38, s34, 18
  s_add_u32 s37, s37, s38
  s_lshl_b32 s38, s34, 15
  s_mov_b32 s39, 32
  s_waitcnt vmcnt(0)
  v_accvgpr_read_b32 v2, a254
  v_accvgpr_read_b32 v3, a255
  v_readfirstlane_b32 s44, v2
  v_readfirstlane_b32 s42, v3
  s_cmp_eq_u32 s44, 0
  s_cbranch_scc1 TRs_103
  s_cmp_eq_u32 s42, 0
  s_cbranch_scc1 TRs_103
  s_cmp_lg_u32 s42, s100
  s_cbranch_scc1 TRf_102
TRs_103:
  s_cmp_lg_u32 s101, 0
  s_cbranch_scc1 NT_104
  s_mov_b32 s42, 0
  v_mov_b32 v3, 0
rdy_106:
  buffer_load_dword v2, v3, s[24:27], 0 offen offset:228 sc1
  s_waitcnt vmcnt(0)
  v_cmp_eq_u32 vcc, 0, v2
  s_cbranch_vccz rdyok_107
  s_sleep 1
  s_add_u32 s42, s42, 1
  s_cmp_lt_u32 s42, s6
  s_cbranch_scc1 rdy_106
  s_mov_b32 s6, 0
rdyok_107:
  v_readfirstlane_b32 s44, v2
  s_cmp_lg_u32 s44, s100
  s_cbranch_scc1 NT_104
  s_mov_b32 s54, s100
  s_branch SWAP_2
NT_104:
  s_mov_b32 s42, 0
  v_mov_b32 v3, 0
rdy_108:
  buffer_load_dword v2, v3, s[24:27], 0 offen offset:224 sc1
  s_waitcnt vmcnt(0)
  v_cmp_eq_u32 vcc, 0, v2
  s_cbranch_vccz rdyok_109
  s_sleep 1
  s_add_u32 s42, s42, 1
  s_cmp_lt_u32 s42, s6
  s_cbranch_scc1 rdy_108
  s_mov_b32 s6, 0
rdyok_109:
TRf_102:
  v_and_b32 v8, 31, v1
  v_lshlrev_b32 v8, 2, v8
  s_mov_b32 s57, 0x7200000
  s_mov_b32 s7, 0
  s_mov_b32 s59, 0
wf_110:
  buffer_load_dword v2, v8, s[8:11], s57 offen sc1
  s_waitcnt vmcnt(0)
  v_cmp_ge_u32 vcc, s7, v2
  s_cbranch_vccz wfok_111
  s_sleep 1
  s_add_u32 s59, s59, 1
  s_cmp_lt_u32 s59, s6
  s_cbranch_scc1 wf_110
  s_mov_b32 s6, 0
wfok_111:
  s_lshl_b32 s56, s32, 1
  s_add_u32 s56, s56, s34
  s_lshl_b32 s56, s56, 2
  s_lshl_b32 s40, s33, 7
  s_add_u32 s56, s56, s40
  s_add_u32 s56, s56, 0x7201000
  s_sub_u32 s7, s34, 2
  s_cmp_eq_u32 s32, 1
  s_cbranch_scc1 QKVv_112
  s_lshl_b32 s40, s4, 10
  s_add_u32 s37, s37, s40
  v_lshlrev_b32 v4, 4, v1
  v_mov_b32 v5, v4
  s_lshl_b32 s48, s4, 13
  s_add_u32 s49, s38, s48
  s_mov_b32 s50, s48
  s_mov_b32 s51, 0
  s_mov_b32 s52, 0
  s_cmp_eq_u32 s32, 2
  s_cselect_b32 s58, 3, 7
  s_cmp_lg_u32 s52, s58
  s_cbranch_scc1 QPp_114
  s_lshl_b32 s75, s33, 7
  s_add_u32 s75, s75, 0x7202040
  s_mov_b32 s58, 0
  v_mov_b32 v9, 0
  s_mov_b32 s59, 0
wf_115:
  buffer_load_dword v2, v9, s[8:11], s75 offen sc1
  s_waitcnt vmcnt(0)
  v_cmp_ge_u32 vcc, s58, v2
  s_cbranch_vccz wfok_116
  s_sleep 1
  s_add_u32 s59, s59, 1
  s_cmp_lt_u32 s59, s6
  s_cbranch_scc1 wf_115
  s_mov_b32 s6, 0
wfok_116:
QPp_114:
  s_cmp_lg_u32 s52, 8
  s_cbranch_scc1 QPd_117
  s_mov_b32 s58, 3
  s_mov_b32 s59, 0
wf_118:
  buffer_load_dword v2, v8, s[8:11], s57 offen sc1
  s_waitcnt vmcnt(0)
  v_cmp_ge_u32 vcc, s58, v2
  s_cbranch_vccz wfok_119
  s_sleep 1
  s_add_u32 s59, s59, 1
  s_cmp_lt_u32 s59, s6
  s_cbranch_scc1 wf_118
  s_mov_b32 s6, 0
wfok_119:
QPd_117:
  s_cmp_lt_u32 s52, s39
  s_cselect_b32 s53, s49, 0
  s_mov_b32 m0, s50
  s_nop 0
  buffer_load_dwordx4 v4, s[8:11], s53 offen offset:0 sc1 lds
  buffer_load_dwordx4 v4, s[8:11], s53 offen offset:1024 sc1 lds
  buffer_load_dwordx4 v4, s[8:11], s53 offen offset:2048 sc1 lds
  buffer_load_dwordx4 v4, s[8:11], s53 offen offset:3072 sc1 lds
  s_add_u32 s53, s53, 4096
  s_add_u32 m0, s50, 4096
  s_nop 0
  buffer_load_dwordx4 v4, s[8:11], s53 offen offset:0 sc1 lds
  buffer_load_dwordx4 v4, s[8:11], s53 offen offset:1024 sc1 lds
  buffer_load_dwordx4 v4, s[8:11], s53 offen offset:2048 sc1 lds
  buffer_load_dwordx4 v4, s[8:11], s53 offen offset:3072 sc1 lds
  s_add_u32 s49, s49, 0x10000
  s_add_u32 s50, s50, 0x8000
  s_and_b32 s50, s50, 0x1ffff
  s_add_u32 s52, s52, 1
  s_cmp_eq_u32 s32, 2
  s_cselect_b32 s58, 3, 7
  s_cmp_lg_u32 s52, s58
  s_cbranch_scc1 QPp_120
  s_lshl_b32 s75, s33, 7
  s_add_u32 s75, s75, 0x7202040
  s_mov_b32 s58, 0
  v_mov_b32 v9, 0
  s_mov_b32 s59, 0
wf_121:
  buffer_load_dword v2, v9, s[8:11], s75 offen sc1
  s_waitcnt vmcnt(0)
  v_cmp_ge_u32 vcc, s58, v2
  s_cbranch_vccz wfok_122
  s_sleep 1
  s_add_u32 s59, s59, 1
  s_cmp_lt_u32 s59, s6
  s_cbranch_scc1 wf_121
  s_mov_b32 s6, 0
wfok_122:
QPp_120:
  s_cmp_lg_u32 s52, 8
  s_cbranch_scc1 QPd_123
  s_mov_b32 s58, 3
  s_mov_b32 s59, 0
wf_124:
  buffer_load_dword v2, v8, s[8:11], s57 offen sc1
  s_waitcnt vmcnt(0)
  v_cmp_ge_u32 vcc, s58, v2
  s_cbranch_vccz wfok_125
  s_sleep 1
  s_add_u32 s59, s59, 1
  s_cmp_lt_u32 s59, s6
  s_cbranch_scc1 wf_124
  s_mov_b32 s6, 0
wfok_125:
QPd_123:
  s_cmp_lt_u32 s52, s39
  s_cselect_b32 s53, s49, 0
  s_mov_b32 m0, s50
  s_nop 0
  buffer_load_dwordx4 v4, s[8:11], s53 offen offset:0 sc1 lds
  buffer_load_dwordx4 v4, s[8:11], s53 offen offset:1024 sc1 lds
  buffer_load_dwordx4 v4, s[8:11], s53 offen offset:2048 sc1 lds
  buffer_load_dwordx4 v4, s[8:11], s53 offen offset:3072 sc1 lds
  s_add_u32 s53, s53, 4096
  s_add_u32 m0, s50, 4096
  s_nop 0
  buffer_load_dwordx4 v4, s[8:11], s53 offen offset:0 sc1 lds
  buffer_load_dwordx4 v4, s[8:11], s53 offen offset:1024 sc1 lds
  buffer_load_dwordx4 v4, s[8:11], s53 offen offset:2048 sc1 lds
  buffer_load_dwordx4 v4, s[8:11], s53 offen offset:3072 sc1 lds
  s_add_u32 s49, s49, 0x10000
  s_add_u32 s50, s50, 0x8000
  s_and_b32 s50, s50, 0x1ffff
  s_add_u32 s52, s52, 1
  s_cmp_eq_u32 s32, 2
  s_cselect_b32 s58, 3, 7
  s_cmp_lg_u32 s52, s58
  s_cbranch_scc1 QPp_126
  s_lshl_b32 s75, s33, 7
  s_add_u32 s75, s75, 0x7202040
  s_mov_b32 s58, 0
  v_mov_b32 v9, 0
  s_mov_b32 s59, 0
wf_127:
  buffer_load_dword v2, v9, s[8:11], s75 offen sc1
  s_waitcnt vmcnt(0)
  v_cmp_ge_u32 vcc, s58, v2
  s_cbranch_vccz wfok_128
  s_sleep 1
  s_add_u32 s59, s59, 1
  s_cmp_lt_u32 s59, s6
  s_cbranch_scc1 wf_127
  s_mov_b32 s6, 0
wfok_128:
QPp_126:
  s_cmp_lg_u32 s52, 8
  s_cbranch_scc1 QPd_129
  s_mov_b32 s58, 3
  s_mov_b32 s59, 0
wf_130:
  buffer_load_dword v2, v8, s[8:11], s57 offen sc1
  s_waitcnt vmcnt(0)
  v_cmp_ge_u32 vcc, s58, v2
  s_cbranch_vccz wfok_131
  s_sleep 1
  s_add_u32 s59, s59, 1
  s_cmp_lt_u32 s59, s6
  s_cbranch_scc1 wf_130
  s_mov_b32 s6, 0
wfok_131:
QPd_129:
  s_cmp_lt_u32 s52, s39
  s_cselect_b32 s53, s49, 0
  s_mov_b32 m0, s50
  s_nop 0
  buffer_load_dwordx4 v4, s[8:11], s53 offen offset:0 sc1 lds
  buffer_load_dwordx4 v4, s[8:11], s53 offen offset:1024 sc1 lds
  buffer_load_dword v7, v4, s[8:11], 0 offen
  buffer_load_dword v7, v4, s[8:11], 0 offen
  s_waitcnt vmcnt(12)
  s_barrier
  ds_read_b128 v[16:19], v5 offset:0
  ds_read_b128 v[20:23], v5 offset:1024
  ds_read_b128 v[24:27], v5 offset:2048
  ds_read_b128 v[28:31], v5 offset:3072
  ds_read_b128 v[32:35], v5 offset:4096
  ds_read_b128 v[36:39], v5 offset:5120
  ds_read_b128 v[40:43], v5 offset:6144
  ds_read_b128 v[44:47], v5 offset:7168
QKloop_132:
  v_add_u32 v6, 0x8000, v5
  v_and_b32 v6, 0x1ffff, v6
  ds_read_b128 v[48:51], v5 offset:8192
  s_waitcnt lgkmcnt(8)
  v_mfma_f32_16x16x32_bf16 v[80:83], v[128:131], v[16:19], 0
  buffer_load_dwordx4 v4, s[8:11], s53 offen offset:2048 sc1 lds
  v_mfma_f32_16x16x32_bf16 v[84:87], v[192:195], v[16:19], 0
  ds_read_b128 v[52:55], v5 offset:9216
  s_waitcnt lgkmcnt(8)
  v_mfma_f32_16x16x32_bf16 v[80:83], v[132:135], v[20:23], v[80:83]
  v_mfma_f32_16x16x32_bf16 v[84:87], v[196:199], v[20:23], v[84:87]
  ds_read_b128 v[56:59], v5 offset:10240
  s_waitcnt lgkmcnt(8)
  v_mfma_f32_16x16x32_bf16 v[80:83], v[136:139], v[24:27], v[80:83]
  v_mfma_f32_16x16x32_bf16 v[84:87], v[200:203], v[24:27], v[84:87]
  ds_read_b128 v[60:63], v5 offset:11264
  s_waitcnt lgkmcnt(8)
  v_mfma_f32_16x16x32_bf16 v[80:83], v[140:143], v[28:31], v[80:83]
  v_mfma_f32_16x16x32_bf16 v[84:87], v[204:207], v[28:31], v[84:87]
  ds_read_b128 v[64:67], v5 offset:12288
  s_waitcnt lgkmcnt(8)
  v_mfma_f32_16x16x32_bf16 v[80:83], v[144:147], v[32:35], v[80:83]
  buffer_load_dwordx4 v4, s[8:11], s53 offen offset:3072 sc1 lds
  v_mfma_f32_16x16x32_bf16 v[84:87], v[208:211], v[32:35], v[84:87]
  ds_read_b128 v[68:71], v5 offset:13312
  s_waitcnt lgkmcnt(8)
  v_mfma_f32_16x16x32_bf16 v[80:83], v[148:151], v[36:39], v[80:83]
  v_mfma_f32_16x16x32_bf16 v[84:87], v[212:215], v[36:39], v[84:87]
  ds_read_b128 v[72:75], v5 offset:14336
  s_waitcnt lgkmcnt(8)
  v_mfma_f32_16x16x32_bf16 v[80:83], v[152:155], v[40:43], v[80:83]
  v_mfma_f32_16x16x32_bf16 v[84:87], v[216:219], v[40:43], v[84:87]
  ds_read_b128 v[76:79], v5 offset:15360
  s_waitcnt lgkmcnt(8)
  v_mfma_f32_16x16x32_bf16 v[80:83], v[156:159], v[44:47], v[80:83]
  v_mfma_f32_16x16x32_bf16 v[84:87], v[220:223], v[44:47], v[84:87]
  ds_read_b128 v[16:19], v5 offset:16384
  s_waitcnt lgkmcnt(8)
  v_mfma_f32_16x16x32_bf16 v[80:83], v[160:163], v[48:51], v[80:83]
  s_add_u32 s53, s53, 4096
  s_add_u32 m0, s50, 4096
  s_nop 0
  buffer_load_dwordx4 v4, s[8:11], s53 offen offset:0 sc1 lds
  v_mfma_f32_16x16x32_bf16 v[84:87], v[224:227], v[48:51], v[84:87]
  ds_read_b128 v[20:23], v5 offset:17408
  s_waitcnt lgkmcnt(8)
  v_mfma_f32_16x16x32_bf16 v[80:83], v[164:167], v[52:55], v[80:83]
  v_mfma_f32_16x16x32_bf16 v[84:87], v[228:231], v[52:55], v[84:87]
  ds_read_b128 v[24:27], v5 offset:18432
  s_waitcnt lgkmcnt(8)
  v_mfma_f32_16x16x32_bf16 v[80:83], v[168:171], v[56:59], v[80:83]
  v_mfma_f32_16x16x32_bf16 v[84:87], v[232:235], v[56:59], v[84:87]
  ds_read_b128 v[28:31], v5 offset:19456
  s_waitcnt lgkmcnt(8)
  v_mfma_f32_16x16x32_bf16 v[80:83], v[172:175], v[60:63], v[80:83]
  v_mfma_f32_16x16x32_bf16 v[84:87], v[236:239], v[60:63], v[84:87]
  ds_read_b128 v[32:35], v5 offset:20480
  s_waitcnt lgkmcnt(8)
  v_mfma_f32_16x16x32_bf16 v[80:83], v[176:179], v[64:67], v[80:83]
  buffer_load_dwordx4 v4, s[8:11], s53 offen offset:1024 sc1 lds
  v_mfma_f32_16x16x32_bf16 v[84:87], v[240:243], v[64:67], v[84:87]
  ds_read_b128 v[36:39], v5 offset:21504
  s_waitcnt lgkmcnt(8)
  v_mfma_f32_16x16x32_bf16 v[80:83], v[180:183], v[68:71], v[80:83]
  v_mfma_f32_16x16x32_bf16 v[84:87], v[244:247], v[68:71], v[84:87]
  ds_read_b128 v[40:43], v5 offset:22528
  s_waitcnt lgkmcnt(8)
  v_mfma_f32_16x16x32_bf16 v[80:83], v[184:187], v[72:75], v[80:83]
  v_mfma_f32_16x16x32_bf16 v[84:87], v[248:251], v[72:75], v[84:87]
  ds_read_b128 v[44:47], v5 offset:23552
  s_waitcnt lgkmcnt(8)
  v_mfma_f32_16x16x32_bf16 v[80:83], v[188:191], v[76:79], v[80:83]
  v_mfma_f32_16x16x32_bf16 v[84:87], v[252:255], v[76:79], v[84:87]
  ds_read_b128 v[48:51], v5 offset:24576
  s_waitcnt lgkmcnt(8)
  v_mfma_f32_16x16x32_bf16 v[88:91], v[128:131], v[16:19], 0
  buffer_load_dwordx4 v4, s[8:11], s53 offen offset:2048 sc1 lds
  v_mfma_f32_16x16x32_bf16 v[92:95], v[192:195], v[16:19], 0
  ds_read_b128 v[52:55], v5 offset:25600
  s_waitcnt lgkmcnt(8)
  v_mfma_f32_16x16x32_bf16 v[88:91], v[132:135], v[20:23], v[88:91]
  v_mfma_f32_16x16x32_bf16 v[92:95], v[196:199], v[20:23], v[92:95]
  ds_read_b128 v[56:59], v5 offset:26624
  s_waitcnt lgkmcnt(8)
  v_mfma_f32_16x16x32_bf16 v[88:91], v[136:139], v[24:27], v[88:91]
  v_mfma_f32_16x16x32_bf16 v[92:95], v[200:203], v[24:27], v[92:95]
  ds_read_b128 v[60:63], v5 offset:27648
  s_waitcnt lgkmcnt(8)
  v_mfma_f32_16x16x32_bf16 v[88:91], v[140:143], v[28:31], v[88:91]
  v_mfma_f32_16x16x32_bf16 v[92:95], v[204:207], v[28:31], v[92:95]
  ds_read_b128 v[64:67], v5 offset:28672
  s_waitcnt lgkmcnt(8)
  v_mfma_f32_16x16x32_bf16 v[88:91], v[144:147], v[32:35], v[88:91]
  buffer_load_dwordx4 v4, s[8:11], s53 offen offset:3072 sc1 lds
  s_add_u32 s49, s49, 0x10000
  s_add_u32 s50, s50, 0x8000
  s_and_b32 s50, s50, 0x1ffff
  s_add_u32 s52, s52, 1
  v_mfma_f32_16x16x32_bf16 v[92:95], v[208:211], v[32:35], v[92:95]
  ds_read_b128 v[68:71], v5 offset:29696
  s_waitcnt lgkmcnt(8)
  v_mfma_f32_16x16x32_bf16 v[88:91], v[148:151], v[36:39], v[88:91]
  v_mfma_f32_16x16x32_bf16 v[92:95], v[212:215], v[36:39], v[92:95]
  ds_read_b128 v[72:75], v5 offset:30720
  s_waitcnt lgkmcnt(8)
  v_mfma_f32_16x16x32_bf16 v[88:91], v[152:155], v[40:43], v[88:91]
  v_mfma_f32_16x16x32_bf16 v[92:95], v[216:219], v[40:43], v[92:95]
  ds_read_b128 v[76:79], v5 offset:31744
  s_waitcnt lgkmcnt(8)
  v_mfma_f32_16x16x32_bf16 v[88:91], v[156:159], v[44:47], v[88:91]
  v_mfma_f32_16x16x32_bf16 v[92:95], v[220:223], v[44:47], v[92:95]
  s_waitcnt vmcnt(10)
  s_barrier
  s_max_i32 s40, s7, 0
  s_cmp_lg_u32 s4, 0
  s_cbranch_scc1 sf_133
  v_mov_b32 v2, s40
  v_mov_b32 v3, 0
  s_mov_b64 exec, 1
  buffer_store_dword v2, v3, s[8:11], s56 offen sc1
  s_mov_b64 exec, -1
sf_133:
  s_add_u32 s7, s7, 2
  ds_read_b128 v[16:19], v6 offset:0
  s_waitcnt lgkmcnt(8)
  v_mfma_f32_16x16x32_bf16 v[88:91], v[160:163], v[48:51], v[88:91]
  s_cmp_eq_u32 s32, 2
  s_cselect_b32 s58, 3, 7
  s_cmp_lg_u32 s52, s58
  s_cbranch_scc1 QPp_134
  s_lshl_b32 s75, s33, 7
  s_add_u32 s75, s75, 0x7202040
  s_mov_b32 s58, 0
  v_mov_b32 v9, 0
  s_mov_b32 s59, 0
wf_135:
  buffer_load_dword v2, v9, s[8:11], s75 offen sc1
  s_waitcnt vmcnt(0)
  v_cmp_ge_u32 vcc, s58, v2
  s_cbranch_vccz wfok_136
  s_sleep 1
  s_add_u32 s59, s59, 1
  s_cmp_lt_u32 s59, s6
  s_cbranch_scc1 wf_135
  s_mov_b32 s6, 0
wfok_136:
QPp_134:
  s_cmp_lg_u32 s52, 8
  s_cbranch_scc1 QPd_137
  s_mov_b32 s58, 3
  s_mov_b32 s59, 0
wf_138:
  buffer_load_dword v2, v8, s[8:11], s57 offen sc1
  s_waitcnt vmcnt(0)
  v_cmp_ge_u32 vcc, s58, v2
  s_cbranch_vccz wfok_139
  s_sleep 1
  s_add_u32 s59, s59, 1
  s_cmp_lt_u32 s59, s6
  s_cbranch_scc1 wf_138
  s_mov_b32 s6, 0
wfok_139:
QPd_137:
  s_cmp_lt_u32 s52, s39
  s_cselect_b32 s53, s49, 0
  s_mov_b32 m0, s50
  s_nop 0
  buffer_load_dwordx4 v4, s[8:11], s53 offen offset:0 sc1 lds
  v_mfma_f32_16x16x32_bf16 v[92:95], v[224:227], v[48:51], v[92:95]
  ds_read_b128 v[20:23], v6 offset:1024
  s_waitcnt lgkmcnt(8)
  v_mfma_f32_16x16x32_bf16 v[88:91], v[164:167], v[52:55], v[88:91]
  v_mfma_f32_16x16x32_bf16 v[92:95], v[228:231], v[52:55], v[92:95]
  ds_read_b128 v[24:27], v6 offset:2048
  s_waitcnt lgkmcnt(8)
  v_mfma_f32_16x16x32_bf16 v[88:91], v[168:171], v[56:59], v[88:91]
  v_mfma_f32_16x16x32_bf16 v[92:95], v[232:235], v[56:59], v[92:95]
  ds_read_b128 v[28:31], v6 offset:3072
  s_waitcnt lgkmcnt(8)
  v_mfma_f32_16x16x32_bf16 v[88:91], v[172:175], v[60:63], v[88:91]
  v_mfma_f32_16x16x32_bf16 v[92:95], v[236:239], v[60:63], v[92:95]
  ds_read_b128 v[32:35], v6 offset:4096
  s_waitcnt lgkmcnt(8)
  v_mfma_f32_16x16x32_bf16 v[88:91], v[176:179], v[64:67], v[88:91]
  buffer_load_dwordx4 v4, s[8:11], s53 offen offset:1024 sc1 lds
  v_mfma_f32_16x16x32_bf16 v[92:95], v[240:243], v[64:67], v[92:95]
  ds_read_b128 v[36:39], v6 offset:5120
  s_waitcnt lgkmcnt(8)
  v_mfma_f32_16x16x32_bf16 v[88:91], v[180:183], v[68:71], v[88:91]
  v_mfma_f32_16x16x32_bf16 v[92:95], v[244:247], v[68:71], v[92:95]
  ds_read_b128 v[40:43], v6 offset:6144
  s_waitcnt lgkmcnt(8)
  v_mfma_f32_16x16x32_bf16 v[88:91], v[184:187], v[72:75], v[88:91]
  v_mfma_f32_16x16x32_bf16 v[92:95], v[248:251], v[72:75], v[92:95]
  ds_read_b128 v[44:47], v6 offset:7168
  s_waitcnt lgkmcnt(8)
  v_mfma_f32_16x16x32_bf16 v[88:91], v[188:191], v[76:79], v[88:91]
  v_mfma_f32_16x16x32_bf16 v[92:95], v[252:255], v[76:79], v[92:95]
  v_cvt_pk_bf16_f32 v112, v80, v81
  v_cvt_pk_bf16_f32 v113, v82, v83
  v_cvt_pk_bf16_f32 v114, v84, v85
  v_cvt_pk_bf16_f32 v115, v86, v87
  v_cvt_pk_bf16_f32 v116, v88, v89
  v_cvt_pk_bf16_f32 v117, v90, v91
  s_nop 1
  v_cvt_pk_bf16_f32 v118, v92, v93
  v_cvt_pk_bf16_f32 v119, v94, v95
  buffer_store_dwordx4 v[112:115], v4, s[8:11], s37 offen sc1
  s_add_u32 s40, s37, 4096
  buffer_store_dwordx4 v[116:119], v4, s[8:11], s40 offen sc1
  s_add_u32 s37, s37, 0x80000
  v_mov_b32 v5, v6
  s_add_u32 s51, s51, 1
  s_cmp_lt_u32 s51, s39
  s_cbranch_scc1 QKloop_132
  s_waitcnt vmcnt(0) lgkmcnt(0)
  s_branch QKVend_113
QKVv_112:
  s_lshl_b32 s40, s4, 11
  s_add_u32 s37, s37, s40
  s_lshl_b32 s41, s34, 17
  s_lshl_b32 s40, s33, 12
  s_add_u32 s41, s41, s40
  s_lshl_b32 s40, s4, 10
  s_add_u32 s41, s41, s40
  s_add_u32 s41, s41, 0x3220000
  v_mov_b32 v120, -1
  v_mov_b32 v121, -1
  v_mov_b32 v122, -1
  v_mov_b32 v123, -1
  v_lshlrev_b32 v4, 4, v1
  v_mov_b32 v5, v4
  s_lshl_b32 s48, s4, 13
  s_add_u32 s49, s38, s48
  s_mov_b32 s50, s48
  s_mov_b32 s51, 0
  s_mov_b32 s52, 0
  s_cmp_eq_u32 s32, 2
  s_cselect_b32 s58, 3, 7
  s_cmp_lg_u32 s52, s58
  s_cbranch_scc1 QPp_140
  s_lshl_b32 s75, s33, 7
  s_add_u32 s75, s75, 0x7202040
  s_mov_b32 s58, 0
  v_mov_b32 v9, 0
  s_mov_b32 s59, 0
wf_141:
  buffer_load_dword v2, v9, s[8:11], s75 offen sc1
  s_waitcnt vmcnt(0)
  v_cmp_ge_u32 vcc, s58, v2
  s_cbranch_vccz wfok_142
  s_sleep 1
  s_add_u32 s59, s59, 1
  s_cmp_lt_u32 s59, s6
  s_cbranch_scc1 wf_141
  s_mov_b32 s6, 0
wfok_142:
QPp_140:
  s_cmp_lg_u32 s52, 8
  s_cbranch_scc1 QPd_143
  s_mov_b32 s58, 3
  s_mov_b32 s59, 0
wf_144:
  buffer_load_dword v2, v8, s[8:11], s57 offen sc1
  s_waitcnt vmcnt(0)
  v_cmp_ge_u32 vcc, s58, v2
  s_cbranch_vccz wfok_145
  s_sleep 1
  s_add_u32 s59, s59, 1
  s_cmp_lt_u32 s59, s6
  s_cbranch_scc1 wf_144
  s_mov_b32 s6, 0
wfok_145:
QPd_143:
  s_cmp_lt_u32 s52, s39
  s_cselect_b32 s53, s49, 0
  s_mov_b32 m0, s50
  s_nop 0
  buffer_load_dwordx4 v4, s[8:11], s53 offen offset:0 sc1 lds
  buffer_load_dwordx4 v4, s[8:11], s53 offen offset:1024 sc1 lds
  buffer_load_dwordx4 v4, s[8:11], s53 offen offset:2048 sc1 lds
  buffer_load_dwordx4 v4, s[8:11], s53 offen offset:3072 sc1 lds
  s_add_u32 s53, s53, 4096
  s_add_u32 m0, s50, 4096
  s_nop 0
  buffer_load_dwordx4 v4, s[8:11], s53 offen offset:0 sc1 lds
  buffer_load_dwordx4 v4, s[8:11], s53 offen offset:1024 sc1 lds
  buffer_load_dwordx4 v4, s[8:11], s53 offen offset:2048 sc1 lds
  buffer_load_dwordx4 v4, s[8:11], s53 offen offset:3072 sc1 lds
  s_add_u32 s49, s49, 0x10000
  s_add_u32 s50, s50, 0x8000
  s_and_b32 s50, s50, 0x1ffff
  s_add_u32 s52, s52, 1
  s_cmp_eq_u32 s32, 2
  s_cselect_b32 s58, 3, 7
  s_cmp_lg_u32 s52, s58
  s_cbranch_scc1 QPp_146
  s_lshl_b32 s75, s33, 7
  s_add_u32 s75, s75, 0x7202040
  s_mov_b32 s58, 0
  v_mov_b32 v9, 0
  s_mov_b32 s59, 0
wf_147:
  buffer_load_dword v2, v9, s[8:11], s75 offen sc1
  s_waitcnt vmcnt(0)
  v_cmp_ge_u32 vcc, s58, v2
  s_cbranch_vccz wfok_148
  s_sleep 1
  s_add_u32 s59, s59, 1
  s_cmp_lt_u32 s59, s6
  s_cbranch_scc1 wf_147
  s_mov_b32 s6, 0
wfok_148:
QPp_146:
  s_cmp_lg_u32 s52, 8
  s_cbranch_scc1 QPd_149
  s_mov_b32 s58, 3
  s_mov_b32 s59, 0
wf_150:
  buffer_load_dword v2, v8, s[8:11], s57 offen sc1
  s_waitcnt vmcnt(0)
  v_cmp_ge_u32 vcc, s58, v2
  s_cbranch_vccz wfok_151
  s_sleep 1
  s_add_u32 s59, s59, 1
  s_cmp_lt_u32 s59, s6
  s_cbranch_scc1 wf_150
  s_mov_b32 s6, 0
wfok_151:
QPd_149:
  s_cmp_lt_u32 s52, s39
  s_cselect_b32 s53, s49, 0
  s_mov_b32 m0, s50
  s_nop 0
  buffer_load_dwordx4 v4, s[8:11], s53 offen offset:0 sc1 lds
  buffer_load_dwordx4 v4, s[8:11], s53 offen offset:1024 sc1 lds
  buffer_load_dwordx4 v4, s[8:11], s53 offen offset:2048 sc1 lds
  buffer_load_dwordx4 v4, s[8:11], s53 offen offset:3072 sc1 lds
  s_add_u32 s53, s53, 4096
  s_add_u32 m0, s50, 4096
  s_nop 0
  buffer_load_dwordx4 v4, s[8:11], s53 offen offset:0 sc1 lds
  buffer_load_dwordx4 v4, s[8:11], s53 offen offset:1024 sc1 lds
  buffer_load_dwordx4 v4, s[8:11], s53 offen offset:2048 sc1 lds
  buffer_load_dwordx4 v4, s[8:11], s53 offen offset:3072 sc1 lds
  s_add_u32 s49, s49, 0x10000
  s_add_u32 s50, s50, 0x8000
  s_and_b32 s50, s50, 0x1ffff
  s_add_u32 s52, s52, 1
  s_cmp_eq_u32 s32, 2
  s_cselect_b32 s58, 3, 7
  s_cmp_lg_u32 s52, s58
  s_cbranch_scc1 QPp_152
  s_lshl_b32 s75, s33, 7
  s_add_u32 s75, s75, 0x7202040
  s_mov_b32 s58, 0
  v_mov_b32 v9, 0
  s_mov_b32 s59, 0
wf_153:
  buffer_load_dword v2, v9, s[8:11], s75 offen sc1
  s_waitcnt vmcnt(0)
  v_cmp_ge_u32 vcc, s58, v2
  s_cbranch_vccz wfok_154
  s_sleep 1
  s_add_u32 s59, s59, 1
  s_cmp_lt_u32 s59, s6
  s_cbranch_scc1 wf_153
  s_mov_b32 s6, 0
wfok_154:
QPp_152:
  s_cmp_lg_u32 s52, 8
  s_cbranch_scc1 QPd_155
  s_mov_b32 s58, 3
  s_mov_b32 s59, 0
wf_156:
  buffer_load_dword v2, v8, s[8:11], s57 offen sc1
  s_waitcnt vmcnt(0)
  v_cmp_ge_u32 vcc, s58, v2
  s_cbranch_vccz wfok_157
  s_sleep 1
  s_add_u32 s59, s59, 1
  s_cmp_lt_u32 s59, s6
  s_cbranch_scc1 wf_156
  s_mov_b32 s6, 0
wfok_157:
QPd_155:
  s_cmp_lt_u32 s52, s39
  s_cselect_b32 s53, s49, 0
  s_mov_b32 m0, s50
  s_nop 0
  buffer_load_dwordx4 v4, s[8:11], s53 offen offset:0 sc1 lds
  buffer_load_dwordx4 v4, s[8:11], s53 offen offset:1024 sc1 lds
  buffer_load_dword v7, v4, s[8:11], 0 offen
  buffer_load_dword v7, v4, s[8:11], 0 offen
  buffer_load_dword v7, v4, s[8:11], 0 offen
  s_waitcnt vmcnt(13)
  s_barrier
  ds_read_b128 v[16:19], v5 offset:0
  ds_read_b128 v[20:23], v5 offset:1024
  ds_read_b128 v[24:27], v5 offset:2048
  ds_read_b128 v[28:31], v5 offset:3072
  ds_read_b128 v[32:35], v5 offset:4096
  ds_read_b128 v[36:39], v5 offset:5120
  ds_read_b128 v[40:43], v5 offset:6144
  ds_read_b128 v[44:47], v5 offset:7168
Vloop_158:
  v_add_u32 v6, 0x8000, v5
  v_and_b32 v6, 0x1ffff, v6
  ds_read_b128 v[48:51], v5 offset:8192
  s_waitcnt lgkmcnt(8)
  v_mfma_f32_16x16x32_bf16 v[80:83], v[16:19], v[128:131], 0
  buffer_load_dwordx4 v4, s[8:11], s53 offen offset:2048 sc1 lds
  v_mfma_f32_16x16x32_bf16 v[84:87], v[16:19], v[192:195], 0
  ds_read_b128 v[52:55], v5 offset:9216
  s_waitcnt lgkmcnt(8)
  v_mfma_f32_16x16x32_bf16 v[80:83], v[20:23], v[132:135], v[80:83]
  v_mfma_f32_16x16x32_bf16 v[84:87], v[20:23], v[196:199], v[84:87]
  ds_read_b128 v[56:59], v5 offset:10240
  s_waitcnt lgkmcnt(8)
  v_mfma_f32_16x16x32_bf16 v[80:83], v[24:27], v[136:139], v[80:83]
  v_mfma_f32_16x16x32_bf16 v[84:87], v[24:27], v[200:203], v[84:87]
  ds_read_b128 v[60:63], v5 offset:11264
  s_waitcnt lgkmcnt(8)
  v_mfma_f32_16x16x32_bf16 v[80:83], v[28:31], v[140:143], v[80:83]
  v_mfma_f32_16x16x32_bf16 v[84:87], v[28:31], v[204:207], v[84:87]
  ds_read_b128 v[64:67], v5 offset:12288
  s_waitcnt lgkmcnt(8)
  v_mfma_f32_16x16x32_bf16 v[80:83], v[32:35], v[144:147], v[80:83]
  buffer_load_dwordx4 v4, s[8:11], s53 offen offset:3072 sc1 lds
  v_mfma_f32_16x16x32_bf16 v[84:87], v[32:35], v[208:211], v[84:87]
  ds_read_b128 v[68:71], v5 offset:13312
  s_waitcnt lgkmcnt(8)
  v_mfma_f32_16x16x32_bf16 v[80:83], v[36:39], v[148:151], v[80:83]
  v_mfma_f32_16x16x32_bf16 v[84:87], v[36:39], v[212:215], v[84:87]
  ds_read_b128 v[72:75], v5 offset:14336
  s_waitcnt lgkmcnt(8)
  v_mfma_f32_16x16x32_bf16 v[80:83], v[40:43], v[152:155], v[80:83]
  v_mfma_f32_16x16x32_bf16 v[84:87], v[40:43], v[216:219], v[84:87]
  ds_read_b128 v[76:79], v5 offset:15360
  s_waitcnt lgkmcnt(8)
  v_mfma_f32_16x16x32_bf16 v[80:83], v[44:47], v[156:159], v[80:83]
  v_mfma_f32_16x16x32_bf16 v[84:87], v[44:47], v[220:223], v[84:87]
  ds_read_b128 v[16:19], v5 offset:16384
  s_waitcnt lgkmcnt(8)
  v_mfma_f32_16x16x32_bf16 v[80:83], v[48:51], v[160:163], v[80:83]
  s_add_u32 s53, s53, 4096
  s_add_u32 m0, s50, 4096
  s_nop 0
  buffer_load_dwordx4 v4, s[8:11], s53 offen offset:0 sc1 lds
  v_mfma_f32_16x16x32_bf16 v[84:87], v[48:51], v[224:227], v[84:87]
  ds_read_b128 v[20:23], v5 offset:17408
  s_waitcnt lgkmcnt(8)
  v_mfma_f32_16x16x32_bf16 v[80:83], v[52:55], v[164:167], v[80:83]
  v_mfma_f32_16x16x32_bf16 v[84:87], v[52:55], v[228:231], v[84:87]
  ds_read_b128 v[24:27], v5 offset:18432
  s_waitcnt lgkmcnt(8)
  v_mfma_f32_16x16x32_bf16 v[80:83], v[56:59], v[168:171], v[80:83]
  v_mfma_f32_16x16x32_bf16 v[84:87], v[56:59], v[232:235], v[84:87]
  ds_read_b128 v[28:31], v5 offset:19456
  s_waitcnt lgkmcnt(8)
  v_mfma_f32_16x16x32_bf16 v[80:83], v[60:63], v[172:175], v[80:83]
  v_mfma_f32_16x16x32_bf16 v[84:87], v[60:63], v[236:239], v[84:87]
  ds_read_b128 v[32:35], v5 offset:20480
  s_waitcnt lgkmcnt(8)
  v_mfma_f32_16x16x32_bf16 v[80:83], v[64:67], v[176:179], v[80:83]
  buffer_load_dwordx4 v4, s[8:11], s53 offen offset:1024 sc1 lds
  v_mfma_f32_16x16x32_bf16 v[84:87], v[64:67], v[240:243], v[84:87]
  ds_read_b128 v[36:39], v5 offset:21504
  s_waitcnt lgkmcnt(8)
  v_mfma_f32_16x16x32_bf16 v[80:83], v[68:71], v[180:183], v[80:83]
  v_mfma_f32_16x16x32_bf16 v[84:87], v[68:71], v[244:247], v[84:87]
  ds_read_b128 v[40:43], v5 offset:22528
  s_waitcnt lgkmcnt(8)
  v_mfma_f32_16x16x32_bf16 v[80:83], v[72:75], v[184:187], v[80:83]
  v_mfma_f32_16x16x32_bf16 v[84:87], v[72:75], v[248:251], v[84:87]
  ds_read_b128 v[44:47], v5 offset:23552
  s_waitcnt lgkmcnt(8)
  v_mfma_f32_16x16x32_bf16 v[80:83], v[76:79], v[188:191], v[80:83]
  v_mfma_f32_16x16x32_bf16 v[84:87], v[76:79], v[252:255], v[84:87]
  ds_read_b128 v[48:51], v5 offset:24576
  s_waitcnt lgkmcnt(8)
  v_mfma_f32_16x16x32_bf16 v[88:91], v[16:19], v[128:131], 0
  buffer_load_dwordx4 v4, s[8:11], s53 offen offset:2048 sc1 lds
  v_mfma_f32_16x16x32_bf16 v[92:95], v[16:19], v[192:195], 0
  ds_read_b128 v[52:55], v5 offset:25600
  s_waitcnt lgkmcnt(8)
  v_mfma_f32_16x16x32_bf16 v[88:91], v[20:23], v[132:135], v[88:91]
  v_mfma_f32_16x16x32_bf16 v[92:95], v[20:23], v[196:199], v[92:95]
  ds_read_b128 v[56:59], v5 offset:26624
  s_waitcnt lgkmcnt(8)
  v_mfma_f32_16x16x32_bf16 v[88:91], v[24:27], v[136:139], v[88:91]
  v_mfma_f32_16x16x32_bf16 v[92:95], v[24:27], v[200:203], v[92:95]
  ds_read_b128 v[60:63], v5 offset:27648
  s_waitcnt lgkmcnt(8)
  v_mfma_f32_16x16x32_bf16 v[88:91], v[28:31], v[140:143], v[88:91]
  v_mfma_f32_16x16x32_bf16 v[92:95], v[28:31], v[204:207], v[92:95]
  ds_read_b128 v[64:67], v5 offset:28672
  s_waitcnt lgkmcnt(8)
  v_mfma_f32_16x16x32_bf16 v[88:91], v[32:35], v[144:147], v[88:91]
  buffer_load_dwordx4 v4, s[8:11], s53 offen offset:3072 sc1 lds
  s_add_u32 s49, s49, 0x10000
  s_add_u32 s50, s50, 0x8000
  s_and_b32 s50, s50, 0x1ffff
  s_add_u32 s52, s52, 1
  v_mfma_f32_16x16x32_bf16 v[92:95], v[32:35], v[208:211], v[92:95]
  ds_read_b128 v[68:71], v5 offset:29696
  s_waitcnt lgkmcnt(8)
  v_mfma_f32_16x16x32_bf16 v[88:91], v[36:39], v[148:151], v[88:91]
  v_mfma_f32_16x16x32_bf16 v[92:95], v[36:39], v[212:215], v[92:95]
  ds_read_b128 v[72:75], v5 offset:30720
  s_waitcnt lgkmcnt(8)
  v_mfma_f32_16x16x32_bf16 v[88:91], v[40:43], v[152:155], v[88:91]
  v_mfma_f32_16x16x32_bf16 v[92:95], v[40:43], v[216:219], v[92:95]
  ds_read_b128 v[76:79], v5 offset:31744
  s_waitcnt lgkmcnt(8)
  v_mfma_f32_16x16x32_bf16 v[88:91], v[44:47], v[156:159], v[88:91]
  v_mfma_f32_16x16x32_bf16 v[92:95], v[44:47], v[220:223], v[92:95]
  s_waitcnt vmcnt(11)
  s_barrier
  s_max_i32 s40, s7, 0
  s_cmp_lg_u32 s4, 0
  s_cbranch_scc1 sf_159
  v_mov_b32 v2, s40
  v_mov_b32 v3, 0
  s_mov_b64 exec, 1
  buffer_store_dword v2, v3, s[8:11], s56 offen sc1
  s_mov_b64 exec, -1
sf_159:
  s_add_u32 s7, s7, 2
  ds_read_b128 v[16:19], v6 offset:0
  s_waitcnt lgkmcnt(8)
  v_mfma_f32_16x16x32_bf16 v[88:91], v[48:51], v[160:163], v[88:91]
  s_cmp_eq_u32 s32, 2
  s_cselect_b32 s58, 3, 7
  s_cmp_lg_u32 s52, s58
  s_cbranch_scc1 QPp_160
  s_lshl_b32 s75, s33, 7
  s_add_u32 s75, s75, 0x7202040
  s_mov_b32 s58, 0
  v_mov_b32 v9, 0
  s_mov_b32 s59, 0
wf_161:
  buffer_load_dword v2, v9, s[8:11], s75 offen sc1
  s_waitcnt vmcnt(0)
  v_cmp_ge_u32 vcc, s58, v2
  s_cbranch_vccz wfok_162
  s_sleep 1
  s_add_u32 s59, s59, 1
  s_cmp_lt_u32 s59, s6
  s_cbranch_scc1 wf_161
  s_mov_b32 s6, 0
wfok_162:
QPp_160:
  s_cmp_lg_u32 s52, 8
  s_cbranch_scc1 QPd_163
  s_mov_b32 s58, 3
  s_mov_b32 s59, 0
wf_164:
  buffer_load_dword v2, v8, s[8:11], s57 offen sc1
  s_waitcnt vmcnt(0)
  v_cmp_ge_u32 vcc, s58, v2
  s_cbranch_vccz wfok_165
  s_sleep 1
  s_add_u32 s59, s59, 1
  s_cmp_lt_u32 s59, s6
  s_cbranch_scc1 wf_164
  s_mov_b32 s6, 0
wfok_165:
QPd_163:
  s_cmp_lt_u32 s52, s39
  s_cselect_b32 s53, s49, 0
  s_mov_b32 m0, s50
  s_nop 0
  buffer_load_dwordx4 v4, s[8:11], s53 offen offset:0 sc1 lds
  v_mfma_f32_16x16x32_bf16 v[92:95], v[48:51], v[224:227], v[92:95]
  ds_read_b128 v[20:23], v6 offset:1024
  s_waitcnt lgkmcnt(8)
  v_mfma_f32_16x16x32_bf16 v[88:91], v[52:55], v[164:167], v[88:91]
  v_mfma_f32_16x16x32_bf16 v[92:95], v[52:55], v[228:231], v[92:95]
  ds_read_b128 v[24:27], v6 offset:2048
  s_waitcnt lgkmcnt(8)
  v_mfma_f32_16x16x32_bf16 v[88:91], v[56:59], v[168:171], v[88:91]
  v_mfma_f32_16x16x32_bf16 v[92:95], v[56:59], v[232:235], v[92:95]
  ds_read_b128 v[28:31], v6 offset:3072
  s_waitcnt lgkmcnt(8)
  v_mfma_f32_16x16x32_bf16 v[88:91], v[60:63], v[172:175], v[88:91]
  v_mfma_f32_16x16x32_bf16 v[92:95], v[60:63], v[236:239], v[92:95]
  ds_read_b128 v[32:35], v6 offset:4096
  s_waitcnt lgkmcnt(8)
  v_mfma_f32_16x16x32_bf16 v[88:91], v[64:67], v[176:179], v[88:91]
  buffer_load_dwordx4 v4, s[8:11], s53 offen offset:1024 sc1 lds
  v_mfma_f32_16x16x32_bf16 v[92:95], v[64:67], v[240:243], v[92:95]
  ds_read_b128 v[36:39], v6 offset:5120
  s_waitcnt lgkmcnt(8)
  v_mfma_f32_16x16x32_bf16 v[88:91], v[68:71], v[180:183], v[88:91]
  v_mfma_f32_16x16x32_bf16 v[92:95], v[68:71], v[244:247], v[92:95]
  ds_read_b128 v[40:43], v6 offset:6144
  s_waitcnt lgkmcnt(8)
  v_mfma_f32_16x16x32_bf16 v[88:91], v[72:75], v[184:187], v[88:91]
  v_mfma_f32_16x16x32_bf16 v[92:95], v[72:75], v[248:251], v[92:95]
  ds_read_b128 v[44:47], v6 offset:7168
  s_waitcnt lgkmcnt(8)
  v_mfma_f32_16x16x32_bf16 v[88:91], v[76:79], v[188:191], v[88:91]
  v_mfma_f32_16x16x32_bf16 v[92:95], v[76:79], v[252:255], v[92:95]
  v_cvt_pk_bf16_f32 v112, v80, v81
  v_cvt_pk_bf16_f32 v113, v82, v83
  s_nop 1
  v_cvt_pk_bf16_f32 v114, v88, v89
  v_cvt_pk_bf16_f32 v115, v90, v91
  v_cvt_pk_bf16_f32 v116, v84, v85
  v_cvt_pk_bf16_f32 v117, v86, v87
  v_cvt_pk_bf16_f32 v118, v92, v93
  v_cvt_pk_bf16_f32 v119, v94, v95
  buffer_store_dwordx4 v[112:115], v4, s[8:11], s37 offen sc1
  buffer_store_dwordx4 v[116:119], v4, s[8:11], s37 offen offset:1024 sc1
  buffer_store_dwordx4 v[120:123], v4, s[8:11], s41 offen sc1
  s_add_u32 s37, s37, 0x80000
  s_add_u32 s41, s41, 0x40000
  v_mov_b32 v5, v6
  s_add_u32 s51, s51, 1
  s_cmp_lt_u32 s51, s39
  s_cbranch_scc1 Vloop_158
  s_waitcnt vmcnt(0) lgkmcnt(0)
QKVend_113:
  s_waitcnt vmcnt(0)
  s_barrier
  s_cmp_lg_u32 s4, 0
  s_cbranch_scc1 sf_166
  v_mov_b32 v2, 0x80
  v_mov_b32 v3, 0
  s_mov_b64 exec, 1
  buffer_store_dword v2, v3, s[8:11], s56 offen sc1
  s_mov_b64 exec, -1
sf_166:
ROLE2_89:
  s_waitcnt vmcnt(0)
  s_barrier
  s_mov_b32 s42, 0
  v_mov_b32 v3, 0
rdy_167:
  buffer_load_dword v2, v3, s[24:27], 0 offen offset:232 sc1
  s_waitcnt vmcnt(0)
  v_cmp_eq_u32 vcc, 0, v2
  s_cbranch_vccz rdyok_168
  s_sleep 1
  s_add_u32 s42, s42, 1
  s_cmp_lt_u32 s42, s6
  s_cbranch_scc1 rdy_167
  s_mov_b32 s6, 0
rdyok_168:
  s_cmp_ge_u32 s54, 4
  s_cbranch_scc1 UR_169
  s_sub_u32 s7, s54, 1
  s_lshl_b32 s56, s7, 12
  s_lshl_b32 s40, s55, 7
  s_add_u32 s56, s56, s40
  s_add_u32 s56, s56, 0x7206000
  s_mov_b32 s72, 0
  s_mov_b32 vcc_lo, s7
  s_mov_b32 vcc_hi, 0
  s_load_dwordx2 s[12:13], s[0:1], 40
  s_lshr_b32 s32, s55, 2
  s_and_b32 s33, s55, 3
  s_lshl_b32 s36, s32, 19
  s_lshl_b32 s37, s33, 8
  s_add_u32 s36, s36, s37
  s_waitcnt lgkmcnt(0)
  s_and_b32 s13, s13, 0xffff
  s_mov_b32 s14, 0x400000
  s_mov_b32 s15, 0x20000
  v_lshrrev_b32 v9, 4, v1
  v_lshlrev_b32 v8, 2, v9
  v_xor_b32 v8, v8, v1
  v_and_b32 v8, 15, v8
  v_lshlrev_b32 v8, 4, v8
  s_mov_b32 s44, 1024
  v_mad_u32_u24 v8, v9, s44, v8
  s_mul_i32 s44, s4, 4096
  s_add_u32 s44, s44, s36
  s_lshl_b32 s45, s4, 10
  s_mov_b32 m0, s45
  s_nop 0
  buffer_load_dwordx4 v8, s[12:15], s44 offen lds
  s_add_u32 s44, s44, 16384
  s_add_u32 s45, s45, 4096
  s_mov_b32 m0, s45
  s_nop 0
  buffer_load_dwordx4 v8, s[12:15], s44 offen lds
  s_add_u32 s44, s44, 16384
  s_add_u32 s45, s45, 4096
  s_mov_b32 m0, s45
  s_nop 0
  buffer_load_dwordx4 v8, s[12:15], s44 offen lds
  s_add_u32 s44, s44, 16384
  s_add_u32 s45, s45, 4096
  s_mov_b32 m0, s45
  s_nop 0
  buffer_load_dwordx4 v8, s[12:15], s44 offen lds
  s_add_u32 s44, s44, 16384
  s_add_u32 s45, s45, 4096
  s_mov_b32 m0, s45
  s_nop 0
  buffer_load_dwordx4 v8, s[12:15], s44 offen lds
  s_add_u32 s44, s44, 16384
  s_add_u32 s45, s45, 4096
  s_mov_b32 m0, s45
  s_nop 0
  buffer_load_dwordx4 v8, s[12:15], s44 offen lds
  s_add_u32 s44, s44, 16384
  s_add_u32 s45, s45, 4096
  s_mov_b32 m0, s45
  s_nop 0
  buffer_load_dwordx4 v8, s[12:15], s44 offen lds
  s_add_u32 s44, s44, 16384
  s_add_u32 s45, s45, 4096
  s_mov_b32 m0, s45
  s_nop 0
  buffer_load_dwordx4 v8, s[12:15], s44 offen lds
  s_add_u32 s44, s44, 16384
  s_add_u32 s45, s45, 4096
  s_mov_b32 m0, s45
  s_nop 0
  buffer_load_dwordx4 v8, s[12:15], s44 offen lds
  s_add_u32 s44, s44, 16384
  s_add_u32 s45, s45, 4096
  s_mov_b32 m0, s45
  s_nop 0
  buffer_load_dwordx4 v8, s[12:15], s44 offen lds
  s_add_u32 s44, s44, 16384
  s_add_u32 s45, s45, 4096
  s_mov_b32 m0, s45
  s_nop 0
  buffer_load_dwordx4 v8, s[12:15], s44 offen lds
  s_add_u32 s44, s44, 16384
  s_add_u32 s45, s45, 4096
  s_mov_b32 m0, s45
  s_nop 0
  buffer_load_dwordx4 v8, s[12:15], s44 offen lds
  s_add_u32 s44, s44, 16384
  s_add_u32 s45, s45, 4096
  s_mov_b32 m0, s45
  s_nop 0
  buffer_load_dwordx4 v8, s[12:15], s44 offen lds
  s_add_u32 s44, s44, 16384
  s_add_u32 s45, s45, 4096
  s_mov_b32 m0, s45
  s_nop 0
  buffer_load_dwordx4 v8, s[12:15], s44 offen lds
  s_add_u32 s44, s44, 16384
  s_add_u32 s45, s45, 4096
  s_mov_b32 m0, s45
  s_nop 0
  buffer_load_dwordx4 v8, s[12:15], s44 offen lds
  s_add_u32 s44, s44, 16384
  s_add_u32 s45, s45, 4096
  s_mov_b32 m0, s45
  s_nop 0
  buffer_load_dwordx4 v8, s[12:15], s44 offen lds
  s_add_u32 s44, s44, 16384
  s_add_u32 s45, s45, 4096
  s_mov_b32 m0, s45
  s_nop 0
  buffer_load_dwordx4 v8, s[12:15], s44 offen lds
  s_add_u32 s44, s44, 16384
  s_add_u32 s45, s45, 4096
  s_mov_b32 m0, s45
  s_nop 0
  buffer_load_dwordx4 v8, s[12:15], s44 offen lds
  s_add_u32 s44, s44, 16384
  s_add_u32 s45, s45, 4096
  s_mov_b32 m0, s45
  s_nop 0
  buffer_load_dwordx4 v8, s[12:15], s44 offen lds
  s_add_u32 s44, s44, 16384
  s_add_u32 s45, s45, 4096
  s_mov_b32 m0, s45
  s_nop 0
  buffer_load_dwordx4 v8, s[12:15], s44 offen lds
  s_add_u32 s44, s44, 16384
  s_add_u32 s45, s45, 4096
  s_mov_b32 m0, s45
  s_nop 0
  buffer_load_dwordx4 v8, s[12:15], s44 offen lds
  s_add_u32 s44, s44, 16384
  s_add_u32 s45, s45, 4096
  s_mov_b32 m0, s45
  s_nop 0
  buffer_load_dwordx4 v8, s[12:15], s44 offen lds
  s_add_u32 s44, s44, 16384
  s_add_u32 s45, s45, 4096
  s_mov_b32 m0, s45
  s_nop 0
  buffer_load_dwordx4 v8, s[12:15], s44 offen lds
  s_add_u32 s44, s44, 16384
  s_add_u32 s45, s45, 4096
  s_mov_b32 m0, s45
  s_nop 0
  buffer_load_dwordx4 v8, s[12:15], s44 offen lds
  s_add_u32 s44, s44, 16384
  s_add_u32 s45, s45, 4096
  s_mov_b32 m0, s45
  s_nop 0
  buffer_load_dwordx4 v8, s[12:15], s44 offen lds
  s_add_u32 s44, s44, 16384
  s_add_u32 s45, s45, 4096
  s_mov_b32 m0, s45
  s_nop 0
  buffer_load_dwordx4 v8, s[12:15], s44 offen lds
  s_add_u32 s44, s44, 16384
  s_add_u32 s45, s45, 4096
  s_mov_b32 m0, s45
  s_nop 0
  buffer_load_dwordx4 v8, s[12:15], s44 offen lds
  s_add_u32 s44, s44, 16384
  s_add_u32 s45, s45, 4096
  s_mov_b32 m0, s45
  s_nop 0
  buffer_load_dwordx4 v8, s[12:15], s44 offen lds
  s_add_u32 s44, s44, 16384
  s_add_u32 s45, s45, 4096
  s_mov_b32 m0, s45
  s_nop 0
  buffer_load_dwordx4 v8, s[12:15], s44 offen lds
  s_add_u32 s44, s44, 16384
  s_add_u32 s45, s45, 4096
  s_mov_b32 m0, s45
  s_nop 0
  buffer_load_dwordx4 v8, s[12:15], s44 offen lds
  s_add_u32 s44, s44, 16384
  s_add_u32 s45, s45, 4096
  s_mov_b32 m0, s45
  s_nop 0
  buffer_load_dwordx4 v8, s[12:15], s44 offen lds
  s_add_u32 s44, s44, 16384
  s_add_u32 s45, s45, 4096
  s_mov_b32 m0, s45
  s_nop 0
  buffer_load_dwordx4 v8, s[12:15], s44 offen lds
BCst_173:
  v_lshrrev_b32 v10, 4, v1
  v_lshlrev_b32 v10, 3, v10
  v_bfe_u32 v12, v1, 2, 2
  v_add_u32 v10, v10, v12
  v_lshlrev_b32 v10, 8, v10
  v_xor_b32 v12, s4, v12
  v_lshl_add_u32 v10, v12, 6, v10
  v_and_b32 v12, 3, v1
  v_lshl_add_u32 v10, v12, 4, v10
  v_add_u32 v11, 0x10000, v10
  s_waitcnt vmcnt(0)
  s_barrier
  ds_read_b64_tr_b16 a[0:1], v10 offset:0
  ds_read_b64_tr_b16 a[2:3], v10 offset:1024
  ds_read_b64_tr_b16 a[64:65], v10 offset:8
  ds_read_b64_tr_b16 a[66:67], v10 offset:1032
  ds_read_b64_tr_b16 a[4:5], v10 offset:8192
  ds_read_b64_tr_b16 a[6:7], v10 offset:9216
  ds_read_b64_tr_b16 a[68:69], v10 offset:8200
  ds_read_b64_tr_b16 a[70:71], v10 offset:9224
  ds_read_b64_tr_b16 a[8:9], v10 offset:16384
  ds_read_b64_tr_b16 a[10:11], v10 offset:17408
  ds_read_b64_tr_b16 a[72:73], v10 offset:16392
  ds_read_b64_tr_b16 a[74:75], v10 offset:17416
  s_waitcnt lgkmcnt(4)
  ds_read_b64_tr_b16 a[12:13], v10 offset:24576
  ds_read_b64_tr_b16 a[14:15], v10 offset:25600
  ds_read_b64_tr_b16 a[76:77], v10 offset:24584
  ds_read_b64_tr_b16 a[78:79], v10 offset:25608
  ds_read_b64_tr_b16 a[16:17], v10 offset:32768
  ds_read_b64_tr_b16 a[18:19], v10 offset:33792
  ds_read_b64_tr_b16 a[80:81], v10 offset:32776
  ds_read_b64_tr_b16 a[82:83], v10 offset:33800
  ds_read_b64_tr_b16 a[20:21], v10 offset:40960
  ds_read_b64_tr_b16 a[22:23], v10 offset:41984
  ds_read_b64_tr_b16 a[84:85], v10 offset:40968
  ds_read_b64_tr_b16 a[86:87], v10 offset:41992
  s_waitcnt lgkmcnt(4)
  ds_read_b64_tr_b16 a[24:25], v10 offset:49152
  ds_read_b64_tr_b16 a[26:27], v10 offset:50176
  ds_read_b64_tr_b16 a[88:89], v10 offset:49160
  ds_read_b64_tr_b16 a[90:91], v10 offset:50184
  ds_read_b64_tr_b16 a[28:29], v10 offset:57344
  ds_read_b64_tr_b16 a[30:31], v10 offset:58368
  ds_read_b64_tr_b16 a[92:93], v10 offset:57352
  ds_read_b64_tr_b16 a[94:95], v10 offset:58376
  ds_read_b64_tr_b16 a[32:33], v11 offset:0
  ds_read_b64_tr_b16 a[34:35], v11 offset:1024
  ds_read_b64_tr_b16 a[96:97], v11 offset:8
  ds_read_b64_tr_b16 a[98:99], v11 offset:1032
  s_waitcnt lgkmcnt(4)
  ds_read_b64_tr_b16 a[36:37], v11 offset:8192
  ds_read_b64_tr_b16 a[38:39], v11 offset:9216
  ds_read_b64_tr_b16 a[100:101], v11 offset:8200
  ds_read_b64_tr_b16 a[102:103], v11 offset:9224
  ds_read_b64_tr_b16 a[40:41], v11 offset:16384
  ds_read_b64_tr_b16 a[42:43], v11 offset:17408
  ds_read_b64_tr_b16 a[104:105], v11 offset:16392
  ds_read_b64_tr_b16 a[106:107], v11 offset:17416
  ds_read_b64_tr_b16 a[44:45], v11 offset:24576
  ds_read_b64_tr_b16 a[46:47], v11 offset:25600
  ds_read_b64_tr_b16 a[108:109], v11 offset:24584
  ds_read_b64_tr_b16 a[110:111], v11 offset:25608
  s_waitcnt lgkmcnt(4)
  ds_read_b64_tr_b16 a[48:49], v11 offset:32768
  ds_read_b64_tr_b16 a[50:51], v11 offset:33792
  ds_read_b64_tr_b16 a[112:113], v11 offset:32776
  ds_read_b64_tr_b16 a[114:115], v11 offset:33800
  ds_read_b64_tr_b16 a[52:53], v11 offset:40960
  ds_read_b64_tr_b16 a[54:55], v11 offset:41984
  ds_read_b64_tr_b16 a[116:117], v11 offset:40968
  ds_read_b64_tr_b16 a[118:119], v11 offset:41992
  ds_read_b64_tr_b16 a[56:57], v11 offset:49152
  ds_read_b64_tr_b16 a[58:59], v11 offset:50176
  ds_read_b64_tr_b16 a[120:121], v11 offset:49160
  ds_read_b64_tr_b16 a[122:123], v11 offset:50184
  s_waitcnt lgkmcnt(4)
  ds_read_b64_tr_b16 a[60:61], v11 offset:57344
  ds_read_b64_tr_b16 a[62:63], v11 offset:58368
  ds_read_b64_tr_b16 a[124:125], v11 offset:57352
  ds_read_b64_tr_b16 a[126:127], v11 offset:58376
  s_waitcnt lgkmcnt(0)
  s_barrier
  v_lshlrev_b32 v4, 4, v1
  v_and_b32 v10, 15, v1
  v_lshrrev_b32 v11, 4, v1
  v_bfe_u32 v12, v1, 2, 2
  v_and_b32 v13, 3, v1
  s_mul_i32 s38, s4, 5120
  s_add_u32 s38, s38, 65536
  v_mul_u32_u24 v14, 320, v11
  v_lshl_add_u32 v14, v10, 3, v14
  v_add_u32 v5, s38, v14
  v_mul_u32_u24 v14, 320, v13
  v_lshrrev_b32 v15, 2, v1
  v_lshl_add_u32 v14, v15, 3, v14
  v_add_u32 v6, s38, v14
  s_lshl_b32 s38, s4, 12
  v_add_u32 v7, s38, v4
  v_mov_b32 v8, v4
  v_lshlrev_b32 v14, 2, v11
  v_add_u32 v15, 0, v14
  v_cmp_gt_u32 s[64:65], v15, v10
  v_add_u32 v15, 1, v14
  v_cmp_gt_u32 s[66:67], v15, v10
  v_add_u32 v15, 2, v14
  v_cmp_gt_u32 s[68:69], v15, v10
  v_add_u32 v15, 3, v14
  v_cmp_gt_u32 s[70:71], v15, v10
  v_mov_b32 v9, 0xff800000
  s_mov_b32 s41, 0x3e0293ee
  s_lshl_b32 s34, s32, 2
  s_add_u32 s34, s34, s4
  s_lshl_b32 s35, s34, 13
  s_lshl_b32 s39, s34, 12
  s_lshl_b32 s40, s33, 2
  s_add_u32 s40, s40, s4
  s_lshl_b32 s40, s40, 8
  s_lshl_b32 s38, s32, 13
  s_add_u32 s40, s40, s38
  s_add_u32 s40, s40, 0x4000000
  v_lshlrev_b32 v184, 16, v12
  v_lshl_add_u32 v184, v11, 6, v184
  v_lshl_add_u32 v184, v13, 4, v184
  v_add_u32 v185, 4096, v184
  s_add_u32 s42, s7, 60
  s_cmp_eq_u32 s7, 0
  s_cselect_b32 s42, 63, s42
  s_lshl_b32 s42, s42, 19
  s_add_u32 s42, s42, s40
  s_add_u32 s43, s42, 0x40000
  v_mov_b32 v188, -1
  v_mov_b32 v189, -1
  v_mov_b32 v190, -1
  v_mov_b32 v191, -1
  buffer_store_dwordx4 v[188:191], v184, s[8:11], s42 offen sc1
  buffer_store_dwordx4 v[188:191], v185, s[8:11], s42 offen sc1
  s_sub_u32 s42, s42, 0x180000
  buffer_store_dwordx4 v[188:191], v184, s[8:11], s43 offen sc1
  buffer_store_dwordx4 v[188:191], v185, s[8:11], s43 offen sc1
  s_sub_u32 s43, s43, 0x180000
  buffer_store_dwordx4 v[188:191], v184, s[8:11], s42 offen sc1
  buffer_store_dwordx4 v[188:191], v185, s[8:11], s42 offen sc1
  s_sub_u32 s42, s42, 0x180000
  buffer_store_dwordx4 v[188:191], v184, s[8:11], s43 offen sc1
  buffer_store_dwordx4 v[188:191], v185, s[8:11], s43 offen sc1
  s_sub_u32 s43, s43, 0x180000
  buffer_store_dwordx4 v[188:191], v184, s[8:11], s42 offen sc1
  buffer_store_dwordx4 v[188:191], v185, s[8:11], s42 offen sc1
  s_sub_u32 s42, s42, 0x180000
  buffer_store_dwordx4 v[188:191], v184, s[8:11], s43 offen sc1
  buffer_store_dwordx4 v[188:191], v185, s[8:11], s43 offen sc1
  s_sub_u32 s43, s43, 0x180000
  s_cmp_lt_u32 s7, s72
  s_cbranch_scc1 wq_174
  v_min_u32 v3, 5, v1
  v_lshlrev_b32 v3, 2, v3
  s_lshl_b32 s57, s34, 7
  s_add_u32 s57, s57, 0x7201000
  s_mov_b32 s59, 0
wf_175:
  buffer_load_dword v2, v3, s[8:11], s57 offen sc1
  s_waitcnt vmcnt(0)
  v_cmp_ge_u32 vcc, s7, v2
  s_cbranch_vccz wfok_176
  s_sleep 1
  s_add_u32 s59, s59, 1
  s_cmp_lt_u32 s59, s6
  s_cbranch_scc1 wf_175
  s_mov_b32 s6, 0
wfok_176:
  v_cmp_gt_u32 vcc, 0x80, v2
  s_cmp_eq_u64 vcc, 0
  s_cselect_b32 s72, 64, 0
wq_174:
  s_lshl_b32 s45, s7, 18
  s_add_u32 s45, s45, s35
  s_add_u32 s43, s45, 0x200000
  buffer_load_dwordx4 a[128:131], v4, s[8:11], s43 offen offset:0 sc1
  buffer_load_dwordx4 a[132:135], v4, s[8:11], s43 offen offset:1024 sc1
  buffer_load_dwordx4 a[136:139], v4, s[8:11], s43 offen offset:2048 sc1
  buffer_load_dwordx4 a[140:143], v4, s[8:11], s43 offen offset:3072 sc1
  s_add_u32 s43, s45, 0x201000
  buffer_load_dwordx4 a[144:147], v4, s[8:11], s43 offen offset:0 sc1
  buffer_load_dwordx4 a[148:151], v4, s[8:11], s43 offen offset:1024 sc1
  buffer_load_dwordx4 a[152:155], v4, s[8:11], s43 offen offset:2048 sc1
  buffer_load_dwordx4 a[156:159], v4, s[8:11], s43 offen offset:3072 sc1
  s_add_u32 s43, s45, 0x1200000
  buffer_load_dwordx4 a[160:163], v4, s[8:11], s43 offen offset:0 sc1
  buffer_load_dwordx4 a[164:167], v4, s[8:11], s43 offen offset:1024 sc1
  buffer_load_dwordx4 a[168:171], v4, s[8:11], s43 offen offset:2048 sc1
  buffer_load_dwordx4 a[172:175], v4, s[8:11], s43 offen offset:3072 sc1
  s_add_u32 s43, s45, 0x1201000
  buffer_load_dwordx4 a[176:179], v4, s[8:11], s43 offen offset:0 sc1
  buffer_load_dwordx4 a[180:183], v4, s[8:11], s43 offen offset:1024 sc1
  buffer_load_dwordx4 a[184:187], v4, s[8:11], s43 offen offset:2048 sc1
  buffer_load_dwordx4 a[188:191], v4, s[8:11], s43 offen offset:3072 sc1
  s_add_u32 s43, s45, 0x2200000
  buffer_load_dwordx4 a[192:195], v4, s[8:11], s43 offen offset:0 sc1
  buffer_load_dwordx4 a[196:199], v4, s[8:11], s43 offen offset:1024 sc1
  buffer_load_dwordx4 a[200:203], v4, s[8:11], s43 offen offset:2048 sc1
  buffer_load_dwordx4 a[204:207], v4, s[8:11], s43 offen offset:3072 sc1
  s_add_u32 s43, s45, 0x2201000
  buffer_load_dwordx4 a[208:211], v4, s[8:11], s43 offen offset:0 sc1
  buffer_load_dwordx4 a[212:215], v4, s[8:11], s43 offen offset:1024 sc1
  buffer_load_dwordx4 a[216:219], v4, s[8:11], s43 offen offset:2048 sc1
  buffer_load_dwordx4 a[220:223], v4, s[8:11], s43 offen offset:3072 sc1
  s_waitcnt vmcnt(0)
BCl_177:
  s_waitcnt vmcnt(4)
  s_lshl_b32 s42, s7, 17
  s_add_u32 s42, s42, s39
  s_add_u32 s42, s42, 0x3220000
  buffer_load_dwordx4 v[112:115], v4, s[8:11], s42 offen offset:0 sc1
  buffer_load_dwordx4 v[116:119], v4, s[8:11], s42 offen offset:1024 sc1
  buffer_load_dwordx4 v[120:123], v4, s[8:11], s42 offen offset:2048 sc1
  buffer_load_dwordx4 v[124:127], v4, s[8:11], s42 offen offset:3072 sc1
  v_mfma_f32_16x16x32_bf16 v[144:147], a[160:163], a[128:131], 0
  v_accvgpr_read_b32 v16, a128
  v_accvgpr_read_b32 v17, a129
  v_mfma_f32_16x16x32_bf16 v[148:151], a[160:163], a[144:147], 0
  v_accvgpr_read_b32 v18, a130
  v_accvgpr_read_b32 v19, a131
  v_mfma_f32_16x16x32_bf16 v[152:155], a[176:179], a[144:147], 0
  v_accvgpr_read_b32 v20, a132
  v_accvgpr_read_b32 v21, a133
  v_mfma_f32_16x16x32_bf16 v[144:147], a[164:167], a[132:135], v[144:147]
  v_accvgpr_read_b32 v22, a134
  v_accvgpr_read_b32 v23, a135
  v_mfma_f32_16x16x32_bf16 v[148:151], a[164:167], a[148:151], v[148:151]
  v_accvgpr_read_b32 v24, a136
  v_accvgpr_read_b32 v25, a137
  v_mfma_f32_16x16x32_bf16 v[152:155], a[180:183], a[148:151], v[152:155]
  v_accvgpr_read_b32 v26, a138
  v_accvgpr_read_b32 v27, a139
  v_mfma_f32_16x16x32_bf16 v[144:147], a[168:171], a[136:139], v[144:147]
  v_accvgpr_read_b32 v28, a140
  v_accvgpr_read_b32 v29, a141
  v_mfma_f32_16x16x32_bf16 v[148:151], a[168:171], a[152:155], v[148:151]
  v_accvgpr_read_b32 v30, a142
  v_accvgpr_read_b32 v31, a143
  v_mfma_f32_16x16x32_bf16 v[152:155], a[184:187], a[152:155], v[152:155]
  v_accvgpr_read_b32 v32, a144
  v_accvgpr_read_b32 v33, a145
  v_mfma_f32_16x16x32_bf16 v[144:147], a[172:175], a[140:143], v[144:147]
  v_accvgpr_read_b32 v34, a146
  v_accvgpr_read_b32 v35, a147
  v_mfma_f32_16x16x32_bf16 v[148:151], a[172:175], a[156:159], v[148:151]
  v_accvgpr_read_b32 v36, a148
  v_accvgpr_read_b32 v37, a149
  v_mfma_f32_16x16x32_bf16 v[152:155], a[188:191], a[156:159], v[152:155]
  v_accvgpr_read_b32 v38, a150
  v_accvgpr_read_b32 v39, a151
  v_accvgpr_read_b32 v40, a152
  v_accvgpr_read_b32 v41, a153
  v_accvgpr_read_b32 v42, a154
  v_accvgpr_read_b32 v43, a155
  v_accvgpr_read_b32 v44, a156
  v_accvgpr_read_b32 v45, a157
  v_accvgpr_read_b32 v46, a158
  v_accvgpr_read_b32 v47, a159
  v_accvgpr_read_b32 v80, a192
  v_accvgpr_read_b32 v81, a193
  v_accvgpr_read_b32 v82, a194
  v_accvgpr_read_b32 v83, a195
  v_accvgpr_read_b32 v84, a196
  v_accvgpr_read_b32 v85, a197
  v_accvgpr_read_b32 v86, a198
  v_accvgpr_read_b32 v87, a199
  v_accvgpr_read_b32 v88, a200
  v_accvgpr_read_b32 v89, a201
  v_accvgpr_read_b32 v90, a202
  v_accvgpr_read_b32 v91, a203
  v_accvgpr_read_b32 v92, a204
  v_accvgpr_read_b32 v93, a205
  v_accvgpr_read_b32 v94, a206
  v_accvgpr_read_b32 v95, a207
  v_accvgpr_read_b32 v96, a208
  v_accvgpr_read_b32 v97, a209
  v_accvgpr_read_b32 v98, a210
  v_accvgpr_read_b32 v99, a211
  v_accvgpr_read_b32 v100, a212
  v_accvgpr_read_b32 v101, a213
  v_accvgpr_read_b32 v102, a214
  v_accvgpr_read_b32 v103, a215
  v_accvgpr_read_b32 v104, a216
  v_accvgpr_read_b32 v105, a217
  v_accvgpr_read_b32 v106, a218
  v_accvgpr_read_b32 v107, a219
  v_accvgpr_read_b32 v108, a220
  v_accvgpr_read_b32 v109, a221
  v_accvgpr_read_b32 v110, a222
  v_accvgpr_read_b32 v111, a223
  v_cndmask_b32 v144, v144, v9, s[64:65]
  v_cndmask_b32 v152, v152, v9, s[64:65]
  v_cndmask_b32 v145, v145, v9, s[66:67]
  v_cndmask_b32 v153, v153, v9, s[66:67]
  v_cndmask_b32 v146, v146, v9, s[68:69]
  v_cndmask_b32 v154, v154, v9, s[68:69]
  v_cndmask_b32 v147, v147, v9, s[70:71]
  v_cndmask_b32 v155, v155, v9, s[70:71]
  v_max_f32 v10, v144, v145
  v_max3_f32 v10, v146, v147, v10
  v_max_f32 v11, v148, v149
  v_max3_f32 v11, v150, v151, v11
  v_max3_f32 v11, v152, v153, v11
  v_max3_f32 v11, v154, v155, v11
  v_mov_b32 v14, v10
  s_nop 1
  v_permlane32_swap_b32 v10, v14
  v_max_f32 v10, v10, v14
  v_mov_b32 v14, v10
  s_nop 1
  v_permlane16_swap_b32 v10, v14
  v_max_f32 v10, v10, v14
  v_mov_b32 v15, v11
  s_nop 1
  v_permlane32_swap_b32 v11, v15
  v_max_f32 v11, v11, v15
  v_mov_b32 v15, v11
  s_nop 1
  v_permlane16_swap_b32 v11, v15
  v_max_f32 v11, v11, v15
  v_mul_f32 v10, s41, v10
  v_fma_f32 v144, v144, s41, -v10
  v_fma_f32 v145, v145, s41, -v10
  v_fma_f32 v146, v146, s41, -v10
  v_fma_f32 v147, v147, s41, -v10
  v_exp_f32 v144, v144
  v_exp_f32 v145, v145
  v_exp_f32 v146, v146
  v_exp_f32 v147, v147
  v_mul_f32 v11, s41, v11
  v_fma_f32 v148, v148, s41, -v11
  v_fma_f32 v149, v149, s41, -v11
  v_fma_f32 v150, v150, s41, -v11
  v_fma_f32 v151, v151, s41, -v11
  v_fma_f32 v152, v152, s41, -v11
  v_fma_f32 v153, v153, s41, -v11
  v_fma_f32 v154, v154, s41, -v11
  v_fma_f32 v155, v155, s41, -v11
  v_exp_f32 v148, v148
  v_exp_f32 v149, v149
  v_exp_f32 v150, v150
  v_exp_f32 v151, v151
  v_exp_f32 v152, v152
  v_exp_f32 v153, v153
  v_exp_f32 v154, v154
  v_exp_f32 v155, v155
  v_add_f32 v12, v144, v145
  v_add_f32 v12, v12, v146
  v_add_f32 v12, v12, v147
  v_add_f32 v13, v148, v149
  v_add_f32 v13, v13, v150
  v_add_f32 v13, v13, v151
  v_add_f32 v13, v13, v152
  v_add_f32 v13, v13, v153
  v_add_f32 v13, v13, v154
  v_add_f32 v13, v13, v155
  v_mov_b32 v166, 0
  v_mov_b32 v167, 0
  v_mov_b32 v173, 0
  v_mov_b32 v174, 0
  v_mov_b32 v177, 0
  v_mov_b32 v178, 0
  s_waitcnt vmcnt(0)
  s_cmp_lt_u32 s7, 3
  s_cbranch_scc1 BCnp_178
  s_sub_u32 s44, s7, 3
  s_lshl_b32 s58, s44, 1
  s_add_u32 s58, s58, 2
  s_waitcnt vmcnt(0)
  s_barrier
  s_cmp_lg_u32 s4, 0
  s_cbranch_scc1 sf_180
  v_mov_b32 v2, s58
  v_mov_b32 v3, 0
  s_mov_b64 exec, 1
  buffer_store_dword v2, v3, s[8:11], s56 offen sc1
  s_mov_b64 exec, -1
sf_180:
BCnp_178:
  s_add_u32 s44, s7, 3
  s_cmp_ge_u32 s44, 64
  s_cbranch_scc1 BCnw_179
  s_cmp_lt_u32 s44, s72
  s_cbranch_scc1 wq_181
  v_min_u32 v3, 5, v1
  v_lshlrev_b32 v3, 2, v3
  s_lshl_b32 s57, s34, 7
  s_add_u32 s57, s57, 0x7201000
  s_mov_b32 s59, 0
wf_182:
  buffer_load_dword v2, v3, s[8:11], s57 offen sc1
  s_waitcnt vmcnt(0)
  v_cmp_ge_u32 vcc, s44, v2
  s_cbranch_vccz wfok_183
  s_sleep 1
  s_add_u32 s59, s59, 1
  s_cmp_lt_u32 s59, s6
  s_cbranch_scc1 wf_182
  s_mov_b32 s6, 0
wfok_183:
  v_cmp_gt_u32 vcc, 0x80, v2
  s_cmp_eq_u64 vcc, 0
  s_cselect_b32 s72, 64, 0
wq_181:
  s_lshl_b32 s45, s44, 18
  s_add_u32 s45, s45, s35
  s_add_u32 s43, s45, 0x200000
  buffer_load_dwordx4 a[128:131], v4, s[8:11], s43 offen offset:0 sc1
  buffer_load_dwordx4 a[132:135], v4, s[8:11], s43 offen offset:1024 sc1
  buffer_load_dwordx4 a[136:139], v4, s[8:11], s43 offen offset:2048 sc1
  buffer_load_dwordx4 a[140:143], v4, s[8:11], s43 offen offset:3072 sc1
  s_add_u32 s43, s45, 0x201000
  buffer_load_dwordx4 a[144:147], v4, s[8:11], s43 offen offset:0 sc1
  buffer_load_dwordx4 a[148:151], v4, s[8:11], s43 offen offset:1024 sc1
  buffer_load_dwordx4 a[152:155], v4, s[8:11], s43 offen offset:2048 sc1
  buffer_load_dwordx4 a[156:159], v4, s[8:11], s43 offen offset:3072 sc1
  s_add_u32 s43, s45, 0x1200000
  buffer_load_dwordx4 a[160:163], v4, s[8:11], s43 offen offset:0 sc1
  buffer_load_dwordx4 a[164:167], v4, s[8:11], s43 offen offset:1024 sc1
  buffer_load_dwordx4 a[168:171], v4, s[8:11], s43 offen offset:2048 sc1
  buffer_load_dwordx4 a[172:175], v4, s[8:11], s43 offen offset:3072 sc1
  s_add_u32 s43, s45, 0x1201000
  buffer_load_dwordx4 a[176:179], v4, s[8:11], s43 offen offset:0 sc1
  buffer_load_dwordx4 a[180:183], v4, s[8:11], s43 offen offset:1024 sc1
  buffer_load_dwordx4 a[184:187], v4, s[8:11], s43 offen offset:2048 sc1
  buffer_load_dwordx4 a[188:191], v4, s[8:11], s43 offen offset:3072 sc1
  s_add_u32 s43, s45, 0x2200000
  buffer_load_dwordx4 a[192:195], v4, s[8:11], s43 offen offset:0 sc1
  buffer_load_dwordx4 a[196:199], v4, s[8:11], s43 offen offset:1024 sc1
  buffer_load_dwordx4 a[200:203], v4, s[8:11], s43 offen offset:2048 sc1
  buffer_load_dwordx4 a[204:207], v4, s[8:11], s43 offen offset:3072 sc1
  s_add_u32 s43, s45, 0x2201000
  buffer_load_dwordx4 a[208:211], v4, s[8:11], s43 offen offset:0 sc1
  buffer_load_dwordx4 a[212:215], v4, s[8:11], s43 offen offset:1024 sc1
  buffer_load_dwordx4 a[216:219], v4, s[8:11], s43 offen offset:2048 sc1
  buffer_load_dwordx4 a[220:223], v4, s[8:11], s43 offen offset:3072 sc1
BCnw_179:
  s_mov_b32 s59, 0
BCk_184:
  v_max3_u32 v2, v112, v116, v120
  v_max_u32 v2, v2, v124
  v_cmp_eq_u32 vcc, -1, v2
  s_cbranch_vccz BCko_185
  s_sleep 2
  buffer_load_dwordx4 v[112:115], v4, s[8:11], s42 offen offset:0 sc1
  buffer_load_dwordx4 v[116:119], v4, s[8:11], s42 offen offset:1024 sc1
  buffer_load_dwordx4 v[120:123], v4, s[8:11], s42 offen offset:2048 sc1
  buffer_load_dwordx4 v[124:127], v4, s[8:11], s42 offen offset:3072 sc1
  s_waitcnt vmcnt(0)
  s_add_u32 s59, s59, 1
  s_cmp_lt_u32 s59, s6
  s_cbranch_scc1 BCk_184
  s_mov_b32 s6, 0
BCko_185:
  ds_write_b32 v5, v112 offset:0
  ds_write_b32 v5, v113 offset:128
  ds_read_b64_tr_b16 v[128:129], v6 offset:0
  ds_read_b64_tr_b16 v[130:131], v6 offset:128
  ds_write_b32 v5, v116 offset:1280
  ds_write_b32 v5, v117 offset:1408
  ds_read_b64_tr_b16 v[132:133], v6 offset:1280
  ds_read_b64_tr_b16 v[134:135], v6 offset:1408
  ds_write_b32 v5, v120 offset:2560
  ds_write_b32 v5, v121 offset:2688
  ds_read_b64_tr_b16 v[136:137], v6 offset:2560
  ds_read_b64_tr_b16 v[138:139], v6 offset:2688
  ds_write_b32 v5, v124 offset:3840
  ds_write_b32 v5, v125 offset:3968
  ds_read_b64_tr_b16 v[140:141], v6 offset:3840
  s_waitcnt lgkmcnt(14)
  ds_read_b64_tr_b16 v[142:143], v6 offset:3968
  s_waitcnt lgkmcnt(12)
  v_mfma_f32_16x16x32_bf16 v[156:159], v[128:131], v[16:19], 0
  v_mfma_f32_16x16x32_bf16 v[160:163], v[128:131], v[32:35], 0
  s_waitcnt lgkmcnt(8)
  v_mfma_f32_16x16x32_bf16 v[156:159], v[132:135], v[20:23], v[156:159]
  v_mfma_f32_16x16x32_bf16 v[160:163], v[132:135], v[36:39], v[160:163]
  s_waitcnt lgkmcnt(2)
  v_mfma_f32_16x16x32_bf16 v[156:159], v[136:139], v[24:27], v[156:159]
  v_mfma_f32_16x16x32_bf16 v[160:163], v[136:139], v[40:43], v[160:163]
  s_waitcnt lgkmcnt(0)
  v_mfma_f32_16x16x32_bf16 v[156:159], v[140:143], v[28:31], v[156:159]
  v_mfma_f32_16x16x32_bf16 v[160:163], v[140:143], v[44:47], v[160:163]
  s_nop 3
  v_mul_f32 v156, s41, v156
  v_mul_f32 v157, s41, v157
  v_max3_f32 v180, v156, v157, v10
  s_nop 0
  v_mul_f32 v160, s41, v160
  v_mul_f32 v161, s41, v161
  v_max3_f32 v181, v160, v161, v11
  v_mov_b32 v14, v180
  v_mov_b32 v15, v181
  s_nop 0
  v_permlane32_swap_b32 v180, v14
  v_permlane32_swap_b32 v181, v15
  v_max_f32 v180, v180, v14
  v_max_f32 v181, v181, v15
  v_mov_b32 v14, v180
  v_mov_b32 v15, v181
  s_nop 0
  v_permlane16_swap_b32 v180, v14
  v_permlane16_swap_b32 v181, v15
  v_max_f32 v180, v180, v14
  v_max_f32 v181, v181, v15
  v_sub_f32 v10, v10, v180
  v_sub_f32 v156, v156, v180
  v_sub_f32 v157, v157, v180
  v_sub_f32 v11, v11, v181
  v_sub_f32 v160, v160, v181
  v_sub_f32 v161, v161, v181
  v_exp_f32 v10, v10
  v_exp_f32 v156, v156
  v_exp_f32 v157, v157
  v_exp_f32 v11, v11
  v_exp_f32 v160, v160
  v_exp_f32 v161, v161
  v_fma_f32 v12, v12, v10, v156
  v_add_f32 v12, v12, v157
  v_fma_f32 v13, v13, v11, v160
  v_add_f32 v13, v13, v161
  v_mov_b32 v14, v12
  v_mov_b32 v15, v13
  s_nop 0
  v_permlane32_swap_b32 v12, v14
  v_permlane32_swap_b32 v13, v15
  v_add_f32 v12, v12, v14
  v_add_f32 v13, v13, v15
  v_mov_b32 v14, v12
  v_mov_b32 v15, v13
  s_nop 0
  v_permlane16_swap_b32 v12, v14
  v_permlane16_swap_b32 v13, v15
  v_add_f32 v12, v12, v14
  v_add_f32 v13, v13, v15
  v_rcp_f32 v12, v12
  v_rcp_f32 v13, v13
  v_mul_f32 v10, v10, v12
  v_mul_f32 v156, v156, v12
  v_mul_f32 v157, v157, v12
  v_mul_f32 v11, v11, v13
  v_mul_f32 v160, v160, v13
  v_mul_f32 v161, v161, v13
  v_mul_f32 v144, v144, v10
  v_mul_f32 v145, v145, v10
  v_mul_f32 v146, v146, v10
  v_mul_f32 v147, v147, v10
  v_mul_f32 v148, v148, v11
  v_mul_f32 v149, v149, v11
  v_mul_f32 v150, v150, v11
  v_mul_f32 v151, v151, v11
  v_mul_f32 v152, v152, v11
  v_mul_f32 v153, v153, v11
  v_mul_f32 v154, v154, v11
  v_mul_f32 v155, v155, v11
  v_cvt_pk_bf16_f32 v164, v144, v145
  v_cvt_pk_bf16_f32 v165, v146, v147
  v_cvt_pk_bf16_f32 v168, v148, v149
  v_cvt_pk_bf16_f32 v169, v150, v151
  v_cvt_pk_bf16_f32 v170, v152, v153
  v_cvt_pk_bf16_f32 v171, v154, v155
  v_cvt_pk_bf16_f32 v172, v156, v157
  v_cvt_pk_bf16_f32 v175, v156, v157
  v_cvt_pk_bf16_f32 v176, v160, v161
  v_cvt_pk_bf16_f32 v179, v160, v161
  v_mfma_f32_16x16x32_bf16 v[192:195], v[80:83], v[164:167], 0
  v_mfma_f32_16x16x32_bf16 v[196:199], v[84:87], v[164:167], 0
  v_mfma_f32_16x16x32_bf16 v[200:203], v[80:83], v[168:171], 0
  v_mfma_f32_16x16x32_bf16 v[204:207], v[84:87], v[168:171], 0
  v_mfma_f32_16x16x16_bf16 v[192:195], v[114:115], v[172:173], v[192:195]
  v_mfma_f32_16x16x16_bf16 v[196:199], v[114:115], v[174:175], v[196:199]
  v_mfma_f32_16x16x16_bf16 v[200:203], v[114:115], v[176:177], v[200:203]
  v_mfma_f32_16x16x16_bf16 v[204:207], v[114:115], v[178:179], v[204:207]
  v_mfma_f32_16x16x32_bf16 v[208:211], v[88:91], v[164:167], 0
  v_mfma_f32_16x16x32_bf16 v[212:215], v[92:95], v[164:167], 0
  v_mfma_f32_16x16x32_bf16 v[216:219], v[88:91], v[168:171], 0
  v_cvt_pk_bf16_f32 v192, v192, v193
  v_cvt_pk_bf16_f32 v193, v194, v195
  v_mfma_f32_16x16x32_bf16 v[220:223], v[92:95], v[168:171], 0
  v_cvt_pk_bf16_f32 v194, v196, v197
  v_cvt_pk_bf16_f32 v195, v198, v199
  v_mfma_f32_16x16x16_bf16 v[208:211], v[118:119], v[172:173], v[208:211]
  ds_write_b128 v7, v[192:195] offset:0
  v_cvt_pk_bf16_f32 v200, v200, v201
  v_mfma_f32_16x16x16_bf16 v[212:215], v[118:119], v[174:175], v[212:215]
  v_cvt_pk_bf16_f32 v201, v202, v203
  v_cvt_pk_bf16_f32 v202, v204, v205
  v_mfma_f32_16x16x16_bf16 v[216:219], v[118:119], v[176:177], v[216:219]
  v_cvt_pk_bf16_f32 v203, v206, v207
  ds_write_b128 v7, v[200:203] offset:16384
  v_mfma_f32_16x16x16_bf16 v[220:223], v[118:119], v[178:179], v[220:223]
  v_mfma_f32_16x16x32_bf16 v[224:227], v[96:99], v[164:167], 0
  v_mfma_f32_16x16x32_bf16 v[228:231], v[100:103], v[164:167], 0
  v_mfma_f32_16x16x32_bf16 v[232:235], v[96:99], v[168:171], 0
  v_cvt_pk_bf16_f32 v208, v208, v209
  v_cvt_pk_bf16_f32 v209, v210, v211
  v_mfma_f32_16x16x32_bf16 v[236:239], v[100:103], v[168:171], 0
  v_cvt_pk_bf16_f32 v210, v212, v213
  v_cvt_pk_bf16_f32 v211, v214, v215
  v_mfma_f32_16x16x16_bf16 v[224:227], v[122:123], v[172:173], v[224:227]
  ds_write_b128 v7, v[208:211] offset:1024
  v_cvt_pk_bf16_f32 v216, v216, v217
  v_mfma_f32_16x16x16_bf16 v[228:231], v[122:123], v[174:175], v[228:231]
  v_cvt_pk_bf16_f32 v217, v218, v219
  v_cvt_pk_bf16_f32 v218, v220, v221
  v_mfma_f32_16x16x16_bf16 v[232:235], v[122:123], v[176:177], v[232:235]
  v_cvt_pk_bf16_f32 v219, v222, v223
  ds_write_b128 v7, v[216:219] offset:17408
  v_mfma_f32_16x16x16_bf16 v[236:239], v[122:123], v[178:179], v[236:239]
  v_mfma_f32_16x16x32_bf16 v[240:243], v[104:107], v[164:167], 0
  v_mfma_f32_16x16x32_bf16 v[244:247], v[108:111], v[164:167], 0
  v_mfma_f32_16x16x32_bf16 v[248:251], v[104:107], v[168:171], 0
  v_cvt_pk_bf16_f32 v224, v224, v225
  v_cvt_pk_bf16_f32 v225, v226, v227
  v_mfma_f32_16x16x32_bf16 v[252:255], v[108:111], v[168:171], 0
  v_cvt_pk_bf16_f32 v226, v228, v229
  v_cvt_pk_bf16_f32 v227, v230, v231
  v_mfma_f32_16x16x16_bf16 v[240:243], v[126:127], v[172:173], v[240:243]
  ds_write_b128 v7, v[224:227] offset:2048
  v_cvt_pk_bf16_f32 v232, v232, v233
  v_mfma_f32_16x16x16_bf16 v[244:247], v[126:127], v[174:175], v[244:247]
  v_cvt_pk_bf16_f32 v233, v234, v235
  v_cvt_pk_bf16_f32 v234, v236, v237
  v_mfma_f32_16x16x16_bf16 v[248:251], v[126:127], v[176:177], v[248:251]
  v_cvt_pk_bf16_f32 v235, v238, v239
  ds_write_b128 v7, v[232:235] offset:18432
  v_mfma_f32_16x16x16_bf16 v[252:255], v[126:127], v[178:179], v[252:255]
  v_cvt_pk_bf16_f32 v240, v240, v241
  v_cvt_pk_bf16_f32 v241, v242, v243
  v_cvt_pk_bf16_f32 v242, v244, v245
  v_cvt_pk_bf16_f32 v243, v246, v247
  ds_write_b128 v7, v[240:243] offset:3072
  v_cvt_pk_bf16_f32 v248, v248, v249
  v_cvt_pk_bf16_f32 v249, v250, v251
  s_nop 0
  v_cvt_pk_bf16_f32 v250, v252, v253
  v_cvt_pk_bf16_f32 v251, v254, v255
  ds_write_b128 v7, v[248:251] offset:19456
  s_waitcnt lgkmcnt(0)
  s_barrier
  ds_read_b128 v[192:195], v8 offset:0
  ds_read_b128 v[196:199], v8 offset:1024
  ds_read_b128 v[200:203], v8 offset:2048
  ds_read_b128 v[204:207], v8 offset:3072
  ds_read_b128 v[208:211], v8 offset:4096
  ds_read_b128 v[212:215], v8 offset:5120
  ds_read_b128 v[216:219], v8 offset:6144
  ds_read_b128 v[220:223], v8 offset:7168
  ds_read_b128 v[224:227], v8 offset:8192
  s_waitcnt lgkmcnt(8)
  v_mfma_f32_16x16x32_bf16 v[144:147], a[0:3], v[192:195], 0
  v_mfma_f32_16x16x32_bf16 v[148:151], a[64:67], v[192:195], 0
  ds_read_b128 v[228:231], v8 offset:9216
  s_waitcnt lgkmcnt(8)
  v_mfma_f32_16x16x32_bf16 v[144:147], a[4:7], v[196:199], v[144:147]
  v_mfma_f32_16x16x32_bf16 v[148:151], a[68:71], v[196:199], v[148:151]
  ds_read_b128 v[232:235], v8 offset:10240
  s_waitcnt lgkmcnt(3)
  v_mfma_f32_16x16x32_bf16 v[144:147], a[8:11], v[200:203], v[144:147]
  v_mfma_f32_16x16x32_bf16 v[148:151], a[72:75], v[200:203], v[148:151]
  ds_read_b128 v[236:239], v8 offset:11264
  v_mfma_f32_16x16x32_bf16 v[144:147], a[12:15], v[204:207], v[144:147]
  v_mfma_f32_16x16x32_bf16 v[148:151], a[76:79], v[204:207], v[148:151]
  ds_read_b128 v[240:243], v8 offset:12288
  v_mfma_f32_16x16x32_bf16 v[144:147], a[16:19], v[208:211], v[144:147]
  v_mfma_f32_16x16x32_bf16 v[148:151], a[80:83], v[208:211], v[148:151]
  ds_read_b128 v[244:247], v8 offset:13312
  v_mfma_f32_16x16x32_bf16 v[144:147], a[20:23], v[212:215], v[144:147]
  v_mfma_f32_16x16x32_bf16 v[148:151], a[84:87], v[212:215], v[148:151]
  ds_read_b128 v[248:251], v8 offset:14336
  v_mfma_f32_16x16x32_bf16 v[144:147], a[24:27], v[216:219], v[144:147]
  v_mfma_f32_16x16x32_bf16 v[148:151], a[88:91], v[216:219], v[148:151]
  ds_read_b128 v[252:255], v8 offset:15360
  v_mfma_f32_16x16x32_bf16 v[144:147], a[28:31], v[220:223], v[144:147]
  v_mfma_f32_16x16x32_bf16 v[148:151], a[92:95], v[220:223], v[148:151]
  ds_read_b128 v[192:195], v8 offset:16384
  s_waitcnt lgkmcnt(2)
  v_mfma_f32_16x16x32_bf16 v[144:147], a[32:35], v[224:227], v[144:147]
  v_mfma_f32_16x16x32_bf16 v[148:151], a[96:99], v[224:227], v[148:151]
  ds_read_b128 v[196:199], v8 offset:17408
  v_mfma_f32_16x16x32_bf16 v[144:147], a[36:39], v[228:231], v[144:147]
  v_mfma_f32_16x16x32_bf16 v[148:151], a[100:103], v[228:231], v[148:151]
  ds_read_b128 v[200:203], v8 offset:18432
  v_mfma_f32_16x16x32_bf16 v[144:147], a[40:43], v[232:235], v[144:147]
  v_mfma_f32_16x16x32_bf16 v[148:151], a[104:107], v[232:235], v[148:151]
  ds_read_b128 v[204:207], v8 offset:19456
  v_mfma_f32_16x16x32_bf16 v[144:147], a[44:47], v[236:239], v[144:147]
  v_mfma_f32_16x16x32_bf16 v[148:151], a[108:111], v[236:239], v[148:151]
  ds_read_b128 v[208:211], v8 offset:20480
  v_mfma_f32_16x16x32_bf16 v[144:147], a[48:51], v[240:243], v[144:147]
  v_mfma_f32_16x16x32_bf16 v[148:151], a[112:115], v[240:243], v[148:151]
  ds_read_b128 v[212:215], v8 offset:21504
  v_mfma_f32_16x16x32_bf16 v[144:147], a[52:55], v[244:247], v[144:147]
  v_mfma_f32_16x16x32_bf16 v[148:151], a[116:119], v[244:247], v[148:151]
  ds_read_b128 v[216:219], v8 offset:22528
  v_mfma_f32_16x16x32_bf16 v[144:147], a[56:59], v[248:251], v[144:147]
  v_mfma_f32_16x16x32_bf16 v[148:151], a[120:123], v[248:251], v[148:151]
  ds_read_b128 v[220:223], v8 offset:23552
  s_waitcnt lgkmcnt(2)
  v_mfma_f32_16x16x32_bf16 v[144:147], a[60:63], v[252:255], v[144:147]
  v_mfma_f32_16x16x32_bf16 v[148:151], a[124:127], v[252:255], v[148:151]
  ds_read_b128 v[224:227], v8 offset:24576
  v_mfma_f32_16x16x32_bf16 v[152:155], a[0:3], v[192:195], 0
  v_mfma_f32_16x16x32_bf16 v[156:159], a[64:67], v[192:195], 0
  s_cmp_lt_u32 s7, 55
  s_cbranch_scc1 hn_186
  s_lshl_b32 s58, s7, 1
  s_add_u32 s58, s58, 1
  s_add_u32 s75, s56, 0xa000
  s_cmp_lg_u32 s4, 0
  s_cbranch_scc1 sf_187
  v_mov_b32 v2, s58
  v_mov_b32 v3, 0
  s_mov_b64 exec, 1
  buffer_store_dword v2, v3, s[8:11], s75 offen sc1
  s_mov_b64 exec, -1
sf_187:
hn_186:
  ds_read_b128 v[228:231], v8 offset:25600
  v_mfma_f32_16x16x32_bf16 v[152:155], a[4:7], v[196:199], v[152:155]
  v_mfma_f32_16x16x32_bf16 v[156:159], a[68:71], v[196:199], v[156:159]
  ds_read_b128 v[232:235], v8 offset:26624
  v_mfma_f32_16x16x32_bf16 v[152:155], a[8:11], v[200:203], v[152:155]
  v_mfma_f32_16x16x32_bf16 v[156:159], a[72:75], v[200:203], v[156:159]
  ds_read_b128 v[236:239], v8 offset:27648
  v_mfma_f32_16x16x32_bf16 v[152:155], a[12:15], v[204:207], v[152:155]
  v_mfma_f32_16x16x32_bf16 v[156:159], a[76:79], v[204:207], v[156:159]
  ds_read_b128 v[240:243], v8 offset:28672
  v_mfma_f32_16x16x32_bf16 v[152:155], a[16:19], v[208:211], v[152:155]
  v_mfma_f32_16x16x32_bf16 v[156:159], a[80:83], v[208:211], v[156:159]
  s_lshl_b32 s42, s7, 19
  s_add_u32 s42, s42, s40
  buffer_store_dwordx4 v[144:147], v184, s[8:11], s42 offen sc1
  buffer_store_dwordx4 v[148:151], v185, s[8:11], s42 offen sc1
  ds_read_b128 v[244:247], v8 offset:29696
  v_mfma_f32_16x16x32_bf16 v[152:155], a[20:23], v[212:215], v[152:155]
  v_mfma_f32_16x16x32_bf16 v[156:159], a[84:87], v[212:215], v[156:159]
  ds_read_b128 v[248:251], v8 offset:30720
  s_waitcnt lgkmcnt(2)
  v_mfma_f32_16x16x32_bf16 v[152:155], a[24:27], v[216:219], v[152:155]
  v_mfma_f32_16x16x32_bf16 v[156:159], a[88:91], v[216:219], v[156:159]
  ds_read_b128 v[252:255], v8 offset:31744
  v_mfma_f32_16x16x32_bf16 v[152:155], a[28:31], v[220:223], v[152:155]
  v_mfma_f32_16x16x32_bf16 v[156:159], a[92:95], v[220:223], v[156:159]
  v_mfma_f32_16x16x32_bf16 v[152:155], a[32:35], v[224:227], v[152:155]
  v_mfma_f32_16x16x32_bf16 v[156:159], a[96:99], v[224:227], v[156:159]
  v_mfma_f32_16x16x32_bf16 v[152:155], a[36:39], v[228:231], v[152:155]
  v_mfma_f32_16x16x32_bf16 v[156:159], a[100:103], v[228:231], v[156:159]
  v_mfma_f32_16x16x32_bf16 v[152:155], a[40:43], v[232:235], v[152:155]
  v_mfma_f32_16x16x32_bf16 v[156:159], a[104:107], v[232:235], v[156:159]
  v_mfma_f32_16x16x32_bf16 v[152:155], a[44:47], v[236:239], v[152:155]
  v_mfma_f32_16x16x32_bf16 v[156:159], a[108:111], v[236:239], v[156:159]
  v_mfma_f32_16x16x32_bf16 v[152:155], a[48:51], v[240:243], v[152:155]
  v_mfma_f32_16x16x32_bf16 v[156:159], a[112:115], v[240:243], v[156:159]
  s_waitcnt lgkmcnt(0)
  v_mfma_f32_16x16x32_bf16 v[152:155], a[52:55], v[244:247], v[152:155]
  v_mfma_f32_16x16x32_bf16 v[156:159], a[116:119], v[244:247], v[156:159]
  v_mfma_f32_16x16x32_bf16 v[152:155], a[56:59], v[248:251], v[152:155]
  v_mfma_f32_16x16x32_bf16 v[156:159], a[120:123], v[248:251], v[156:159]
  v_mfma_f32_16x16x32_bf16 v[152:155], a[60:63], v[252:255], v[152:155]
  v_mfma_f32_16x16x32_bf16 v[156:159], a[124:127], v[252:255], v[156:159]
  s_add_u32 s42, s42, 0x40000
  s_nop 2
  buffer_store_dwordx4 v[152:155], v184, s[8:11], s42 offen sc1
  s_nop 2
  buffer_store_dwordx4 v[156:159], v185, s[8:11], s42 offen sc1
  v_xor_b32 v7, 0x8000, v7
  v_xor_b32 v8, 0x8000, v8
  s_add_u32 s7, s7, 3
  s_cmp_lt_u32 s7, 64
  s_cbranch_scc1 BCl_177
  s_sub_u32 s44, s7, 3
  s_lshl_b32 s58, s44, 1
  s_add_u32 s58, s58, 2
  s_waitcnt vmcnt(0)
  s_barrier
  s_cmp_lg_u32 s4, 0
  s_cbranch_scc1 sf_188
  v_mov_b32 v2, s58
  v_mov_b32 v3, 0
  s_mov_b64 exec, 1
  buffer_store_dword v2, v3, s[8:11], s56 offen sc1
  s_mov_b64 exec, -1
sf_188:
  s_branch FIN_172
UR_169:
  s_cmp_eq_u32 s54, 7
  s_cbranch_scc1 DN_170
  s_sub_u32 s7, s54, 4
  s_lshl_b32 s57, s7, 12
  s_cmp_ge_u32 s55, 22
  s_cbranch_scc1 RD_171
  s_lshl_b32 s40, s55, 7
  s_add_u32 s56, s57, s40
  s_add_u32 s56, s56, 0x720c000
  s_add_u32 s57, s57, 0x7209000
  v_and_b32 v13, 7, v1
  v_lshlrev_b32 v13, 7, v13
  s_load_dwordx2 s[12:13], s[0:1], 64
  s_load_dwordx2 s[16:17], s[0:1], 72
  v_lshrrev_b32 v8, 3, v1
  s_mov_b32 s32, 2752
  v_mul_lo_u32 v8, v8, s32
  v_and_b32 v9, 7, v1
  v_lshl_add_u32 v8, v9, 4, v8
  s_lshl_b32 s33, s55, 7
  s_mul_i32 s34, s4, 22016
  s_add_u32 s33, s33, s34
  v_add_u32 v8, s33, v8
  s_lshl_b32 s35, s4, 10
  s_waitcnt lgkmcnt(0)
  s_and_b32 s13, s13, 0xffff
  s_mov_b32 s14, 0x158000
  s_mov_b32 s15, 0x20000
  s_and_b32 s17, s17, 0xffff
  s_mov_b32 s18, 0x158000
  s_mov_b32 s19, 0x20000
  s_add_u32 m0, s35, 0
  s_nop 0
  buffer_load_dwordx4 v8, s[12:15], 0 offen lds
  s_add_u32 m0, s35, 65536
  s_nop 0
  buffer_load_dwordx4 v8, s[16:19], 0 offen lds
  s_waitcnt vmcnt(3)
  v_add_u32 v8, 88064, v8
  s_add_u32 m0, s35, 4096
  s_nop 0
  buffer_load_dwordx4 v8, s[12:15], 0 offen lds
  s_add_u32 m0, s35, 69632
  s_nop 0
  buffer_load_dwordx4 v8, s[16:19], 0 offen lds
  s_waitcnt vmcnt(3)
  v_add_u32 v8, 88064, v8
  s_add_u32 m0, s35, 8192
  s_nop 0
  buffer_load_dwordx4 v8, s[12:15], 0 offen lds
  s_add_u32 m0, s35, 73728
  s_nop 0
  buffer_load_dwordx4 v8, s[16:19], 0 offen lds
  s_waitcnt vmcnt(3)
  v_add_u32 v8, 88064, v8
  s_add_u32 m0, s35, 12288
  s_nop 0
  buffer_load_dwordx4 v8, s[12:15], 0 offen lds
  s_add_u32 m0, s35, 77824
  s_nop 0
  buffer_load_dwordx4 v8, s[16:19], 0 offen lds
  s_waitcnt vmcnt(3)
  v_add_u32 v8, 88064, v8
  s_add_u32 m0, s35, 16384
  s_nop 0
  buffer_load_dwordx4 v8, s[12:15], 0 offen lds
  s_add_u32 m0, s35, 81920
  s_nop 0
  buffer_load_dwordx4 v8, s[16:19], 0 offen lds
  s_waitcnt vmcnt(3)
  v_add_u32 v8, 88064, v8
  s_add_u32 m0, s35, 20480
  s_nop 0
  buffer_load_dwordx4 v8, s[12:15], 0 offen lds
  s_add_u32 m0, s35, 86016
  s_nop 0
  buffer_load_dwordx4 v8, s[16:19], 0 offen lds
  s_waitcnt vmcnt(3)
  v_add_u32 v8, 88064, v8
  s_add_u32 m0, s35, 24576
  s_nop 0
  buffer_load_dwordx4 v8, s[12:15], 0 offen lds
  s_add_u32 m0, s35, 90112
  s_nop 0
  buffer_load_dwordx4 v8, s[16:19], 0 offen lds
  s_waitcnt vmcnt(3)
  v_add_u32 v8, 88064, v8
  s_add_u32 m0, s35, 28672
  s_nop 0
  buffer_load_dwordx4 v8, s[12:15], 0 offen lds
  s_add_u32 m0, s35, 94208
  s_nop 0
  buffer_load_dwordx4 v8, s[16:19], 0 offen lds
  s_waitcnt vmcnt(3)
  v_add_u32 v8, 88064, v8
  s_add_u32 m0, s35, 32768
  s_nop 0
  buffer_load_dwordx4 v8, s[12:15], 0 offen lds
  s_add_u32 m0, s35, 98304
  s_nop 0
  buffer_load_dwordx4 v8, s[16:19], 0 offen lds
  s_waitcnt vmcnt(3)
  v_add_u32 v8, 88064, v8
  s_add_u32 m0, s35, 36864
  s_nop 0
  buffer_load_dwordx4 v8, s[12:15], 0 offen lds
  s_add_u32 m0, s35, 102400
  s_nop 0
  buffer_load_dwordx4 v8, s[16:19], 0 offen lds
  s_waitcnt vmcnt(3)
  v_add_u32 v8, 88064, v8
  s_add_u32 m0, s35, 40960
  s_nop 0
  buffer_load_dwordx4 v8, s[12:15], 0 offen lds
  s_add_u32 m0, s35, 106496
  s_nop 0
  buffer_load_dwordx4 v8, s[16:19], 0 offen lds
  s_waitcnt vmcnt(3)
  v_add_u32 v8, 88064, v8
  s_add_u32 m0, s35, 45056
  s_nop 0
  buffer_load_dwordx4 v8, s[12:15], 0 offen lds
  s_add_u32 m0, s35, 110592
  s_nop 0
  buffer_load_dwordx4 v8, s[16:19], 0 offen lds
  s_waitcnt vmcnt(3)
  v_add_u32 v8, 88064, v8
  s_add_u32 m0, s35, 49152
  s_nop 0
  buffer_load_dwordx4 v8, s[12:15], 0 offen lds
  s_add_u32 m0, s35, 114688
  s_nop 0
  buffer_load_dwordx4 v8, s[16:19], 0 offen lds
  s_waitcnt vmcnt(3)
  v_add_u32 v8, 88064, v8
  s_add_u32 m0, s35, 53248
  s_nop 0
  buffer_load_dwordx4 v8, s[12:15], 0 offen lds
  s_add_u32 m0, s35, 118784
  s_nop 0
  buffer_load_dwordx4 v8, s[16:19], 0 offen lds
  s_waitcnt vmcnt(3)
  v_add_u32 v8, 88064, v8
  s_add_u32 m0, s35, 57344
  s_nop 0
  buffer_load_dwordx4 v8, s[12:15], 0 offen lds
  s_add_u32 m0, s35, 122880
  s_nop 0
  buffer_load_dwordx4 v8, s[16:19], 0 offen lds
  s_waitcnt vmcnt(3)
  v_add_u32 v8, 88064, v8
  s_add_u32 m0, s35, 61440
  s_nop 0
  buffer_load_dwordx4 v8, s[12:15], 0 offen lds
  s_add_u32 m0, s35, 126976
  s_nop 0
  buffer_load_dwordx4 v8, s[16:19], 0 offen lds
  s_waitcnt vmcnt(3)
  v_lshrrev_b32 v10, 4, v1
  v_bfe_u32 v12, v1, 2, 2
  v_lshl_add_u32 v10, v10, 3, v12
  v_lshlrev_b32 v10, 7, v10
  v_and_b32 v12, 3, v1
  v_lshl_add_u32 v10, v12, 4, v10
  s_lshr_b32 s36, s4, 1
  s_lshl_b32 s37, s36, 6
  v_add_u32 v10, s37, v10
  v_add_u32 v11, 0x10000, v10
  s_waitcnt vmcnt(0)
  s_barrier
  ds_read_b64_tr_b16 a[0:1], v10 offset:0
  ds_read_b64_tr_b16 a[2:3], v10 offset:512
  ds_read_b64_tr_b16 a[64:65], v10 offset:8
  ds_read_b64_tr_b16 a[66:67], v10 offset:520
  ds_read_b64_tr_b16 a[128:129], v11 offset:0
  ds_read_b64_tr_b16 a[130:131], v11 offset:512
  ds_read_b64_tr_b16 a[192:193], v11 offset:8
  ds_read_b64_tr_b16 a[194:195], v11 offset:520
  s_waitcnt lgkmcnt(4)
  ds_read_b64_tr_b16 a[4:5], v10 offset:4096
  ds_read_b64_tr_b16 a[6:7], v10 offset:4608
  ds_read_b64_tr_b16 a[68:69], v10 offset:4104
  ds_read_b64_tr_b16 a[70:71], v10 offset:4616
  ds_read_b64_tr_b16 a[132:133], v11 offset:4096
  ds_read_b64_tr_b16 a[134:135], v11 offset:4608
  ds_read_b64_tr_b16 a[196:197], v11 offset:4104
  ds_read_b64_tr_b16 a[198:199], v11 offset:4616
  s_waitcnt lgkmcnt(4)
  ds_read_b64_tr_b16 a[8:9], v10 offset:8192
  ds_read_b64_tr_b16 a[10:11], v10 offset:8704
  ds_read_b64_tr_b16 a[72:73], v10 offset:8200
  ds_read_b64_tr_b16 a[74:75], v10 offset:8712
  ds_read_b64_tr_b16 a[136:137], v11 offset:8192
  ds_read_b64_tr_b16 a[138:139], v11 offset:8704
  ds_read_b64_tr_b16 a[200:201], v11 offset:8200
  ds_read_b64_tr_b16 a[202:203], v11 offset:8712
  s_waitcnt lgkmcnt(4)
  ds_read_b64_tr_b16 a[12:13], v10 offset:12288
  ds_read_b64_tr_b16 a[14:15], v10 offset:12800
  ds_read_b64_tr_b16 a[76:77], v10 offset:12296
  ds_read_b64_tr_b16 a[78:79], v10 offset:12808
  ds_read_b64_tr_b16 a[140:141], v11 offset:12288
  ds_read_b64_tr_b16 a[142:143], v11 offset:12800
  ds_read_b64_tr_b16 a[204:205], v11 offset:12296
  ds_read_b64_tr_b16 a[206:207], v11 offset:12808
  s_waitcnt lgkmcnt(4)
  ds_read_b64_tr_b16 a[16:17], v10 offset:16384
  ds_read_b64_tr_b16 a[18:19], v10 offset:16896
  ds_read_b64_tr_b16 a[80:81], v10 offset:16392
  ds_read_b64_tr_b16 a[82:83], v10 offset:16904
  ds_read_b64_tr_b16 a[144:145], v11 offset:16384
  ds_read_b64_tr_b16 a[146:147], v11 offset:16896
  ds_read_b64_tr_b16 a[208:209], v11 offset:16392
  ds_read_b64_tr_b16 a[210:211], v11 offset:16904
  s_waitcnt lgkmcnt(4)
  ds_read_b64_tr_b16 a[20:21], v10 offset:20480
  ds_read_b64_tr_b16 a[22:23], v10 offset:20992
  ds_read_b64_tr_b16 a[84:85], v10 offset:20488
  ds_read_b64_tr_b16 a[86:87], v10 offset:21000
  ds_read_b64_tr_b16 a[148:149], v11 offset:20480
  ds_read_b64_tr_b16 a[150:151], v11 offset:20992
  ds_read_b64_tr_b16 a[212:213], v11 offset:20488
  ds_read_b64_tr_b16 a[214:215], v11 offset:21000
  s_waitcnt lgkmcnt(4)
  ds_read_b64_tr_b16 a[24:25], v10 offset:24576
  ds_read_b64_tr_b16 a[26:27], v10 offset:25088
  ds_read_b64_tr_b16 a[88:89], v10 offset:24584
  ds_read_b64_tr_b16 a[90:91], v10 offset:25096
  ds_read_b64_tr_b16 a[152:153], v11 offset:24576
  ds_read_b64_tr_b16 a[154:155], v11 offset:25088
  ds_read_b64_tr_b16 a[216:217], v11 offset:24584
  ds_read_b64_tr_b16 a[218:219], v11 offset:25096
  s_waitcnt lgkmcnt(4)
  ds_read_b64_tr_b16 a[28:29], v10 offset:28672
  ds_read_b64_tr_b16 a[30:31], v10 offset:29184
  ds_read_b64_tr_b16 a[92:93], v10 offset:28680
  ds_read_b64_tr_b16 a[94:95], v10 offset:29192
  ds_read_b64_tr_b16 a[156:157], v11 offset:28672
  ds_read_b64_tr_b16 a[158:159], v11 offset:29184
  ds_read_b64_tr_b16 a[220:221], v11 offset:28680
  ds_read_b64_tr_b16 a[222:223], v11 offset:29192
  s_waitcnt lgkmcnt(4)
  ds_read_b64_tr_b16 a[32:33], v10 offset:32768
  ds_read_b64_tr_b16 a[34:35], v10 offset:33280
  ds_read_b64_tr_b16 a[96:97], v10 offset:32776
  ds_read_b64_tr_b16 a[98:99], v10 offset:33288
  ds_read_b64_tr_b16 a[160:161], v11 offset:32768
  ds_read_b64_tr_b16 a[162:163], v11 offset:33280
  ds_read_b64_tr_b16 a[224:225], v11 offset:32776
  ds_read_b64_tr_b16 a[226:227], v11 offset:33288
  s_waitcnt lgkmcnt(4)
  ds_read_b64_tr_b16 a[36:37], v10 offset:36864
  ds_read_b64_tr_b16 a[38:39], v10 offset:37376
  ds_read_b64_tr_b16 a[100:101], v10 offset:36872
  ds_read_b64_tr_b16 a[102:103], v10 offset:37384
  ds_read_b64_tr_b16 a[164:165], v11 offset:36864
  ds_read_b64_tr_b16 a[166:167], v11 offset:37376
  ds_read_b64_tr_b16 a[228:229], v11 offset:36872
  ds_read_b64_tr_b16 a[230:231], v11 offset:37384
  s_waitcnt lgkmcnt(4)
  ds_read_b64_tr_b16 a[40:41], v10 offset:40960
  ds_read_b64_tr_b16 a[42:43], v10 offset:41472
  ds_read_b64_tr_b16 a[104:105], v10 offset:40968
  ds_read_b64_tr_b16 a[106:107], v10 offset:41480
  ds_read_b64_tr_b16 a[168:169], v11 offset:40960
  ds_read_b64_tr_b16 a[170:171], v11 offset:41472
  ds_read_b64_tr_b16 a[232:233], v11 offset:40968
  ds_read_b64_tr_b16 a[234:235], v11 offset:41480
  s_waitcnt lgkmcnt(4)
  ds_read_b64_tr_b16 a[44:45], v10 offset:45056
  ds_read_b64_tr_b16 a[46:47], v10 offset:45568
  ds_read_b64_tr_b16 a[108:109], v10 offset:45064
  ds_read_b64_tr_b16 a[110:111], v10 offset:45576
  ds_read_b64_tr_b16 a[172:173], v11 offset:45056
  ds_read_b64_tr_b16 a[174:175], v11 offset:45568
  ds_read_b64_tr_b16 a[236:237], v11 offset:45064
  ds_read_b64_tr_b16 a[238:239], v11 offset:45576
  s_waitcnt lgkmcnt(4)
  ds_read_b64_tr_b16 a[48:49], v10 offset:49152
  ds_read_b64_tr_b16 a[50:51], v10 offset:49664
  ds_read_b64_tr_b16 a[112:113], v10 offset:49160
  ds_read_b64_tr_b16 a[114:115], v10 offset:49672
  ds_read_b64_tr_b16 a[176:177], v11 offset:49152
  ds_read_b64_tr_b16 a[178:179], v11 offset:49664
  ds_read_b64_tr_b16 a[240:241], v11 offset:49160
  ds_read_b64_tr_b16 a[242:243], v11 offset:49672
  s_waitcnt lgkmcnt(4)
  ds_read_b64_tr_b16 a[52:53], v10 offset:53248
  ds_read_b64_tr_b16 a[54:55], v10 offset:53760
  ds_read_b64_tr_b16 a[116:117], v10 offset:53256
  ds_read_b64_tr_b16 a[118:119], v10 offset:53768
  ds_read_b64_tr_b16 a[180:181], v11 offset:53248
  ds_read_b64_tr_b16 a[182:183], v11 offset:53760
  ds_read_b64_tr_b16 a[244:245], v11 offset:53256
  ds_read_b64_tr_b16 a[246:247], v11 offset:53768
  s_waitcnt lgkmcnt(4)
  ds_read_b64_tr_b16 a[56:57], v10 offset:57344
  ds_read_b64_tr_b16 a[58:59], v10 offset:57856
  ds_read_b64_tr_b16 a[120:121], v10 offset:57352
  ds_read_b64_tr_b16 a[122:123], v10 offset:57864
  ds_read_b64_tr_b16 a[184:185], v11 offset:57344
  ds_read_b64_tr_b16 a[186:187], v11 offset:57856
  ds_read_b64_tr_b16 a[248:249], v11 offset:57352
  ds_read_b64_tr_b16 a[250:251], v11 offset:57864
  s_waitcnt lgkmcnt(4)
  ds_read_b64_tr_b16 a[60:61], v10 offset:61440
  ds_read_b64_tr_b16 a[62:63], v10 offset:61952
  ds_read_b64_tr_b16 a[124:125], v10 offset:61448
  ds_read_b64_tr_b16 a[126:127], v10 offset:61960
  ds_read_b64_tr_b16 a[188:189], v11 offset:61440
  ds_read_b64_tr_b16 a[190:191], v11 offset:61952
  ds_read_b64_tr_b16 a[252:253], v11 offset:61448
  ds_read_b64_tr_b16 a[254:255], v11 offset:61960
  s_waitcnt lgkmcnt(4)
  s_waitcnt lgkmcnt(0)
  s_barrier
  s_and_b32 s37, s4, 1
  s_lshl_b32 s39, s55, 1
  s_add_u32 s39, s39, s36
  v_lshlrev_b32 v4, 4, v1
  s_cmp_lt_u32 s39, 43
  s_cselect_b32 s40, 0, 0x40000000
  v_add_u32 v12, s40, v4
  s_lshl_b32 s39, s39, 10
  s_mul_i32 s40, s7, 88064
  s_add_u32 s39, s39, s40
  s_mul_i32 s40, s37, 44032
  s_add_u32 s39, s39, s40
  s_add_u32 s39, s39, 0x6400000
  s_lshl_b32 s38, s7, 15
  s_add_u32 s38, s38, 0x6200000
  s_mov_b32 s41, 0xbfb8aa3b
  s_lshl_b32 s40, s37, 14
  v_add_u32 v5, s40, v4
  s_lshl_b32 s48, s36, 10
  s_add_u32 s48, s48, s40
  s_add_u32 s38, s38, s48
  s_add_u32 s49, s7, 60
  s_cmp_eq_u32 s7, 0
  s_cselect_b32 s49, 63, s49
  s_sub_u32 s49, s49, s7
  s_mul_i32 s49, s49, 88064
  s_add_u32 s49, s49, s39
  v_mov_b32 v16, -1
  v_mov_b32 v17, -1
  v_mov_b32 v18, -1
  v_mov_b32 v19, -1
  buffer_store_dwordx4 v[16:19], v12, s[8:11], s49 offen sc1
  s_sub_u32 s49, s49, 264192
  buffer_store_dwordx4 v[16:19], v12, s[8:11], s49 offen sc1
  s_sub_u32 s49, s49, 264192
  buffer_store_dwordx4 v[16:19], v12, s[8:11], s49 offen sc1
  s_sub_u32 s49, s49, 264192
  s_waitcnt vmcnt(0)
Ul_189:
  s_cmp_lt_u32 s7, 55
  s_cselect_b32 s75, 0, 0xa000
  s_addc_u32 s58, s7, s7
  s_add_u32 s75, s75, s57
  s_cmp_lg_u32 s4, 0
  s_cbranch_scc1 wfok_194
  s_mov_b32 s59, 0
wf_193:
  buffer_load_dword v2, v13, s[8:11], s75 offen sc1
  s_waitcnt vmcnt(0)
  v_cmp_ge_u32 vcc, s58, v2
  s_cbranch_vccz wfok_194
  s_sleep 1
  s_add_u32 s59, s59, 1
  s_cmp_lt_u32 s59, s6
  s_cbranch_scc1 wf_193
  s_mov_b32 s6, 0
wfok_194:
  s_barrier
  s_add_u32 m0, s48, 0
  s_add_u32 s49, s38, 0
  buffer_load_dwordx4 v4, s[8:11], s49 offen sc1 lds
  s_add_u32 m0, s48, 2048
  s_add_u32 s49, s38, 2048
  buffer_load_dwordx4 v4, s[8:11], s49 offen sc1 lds
  s_add_u32 m0, s48, 4096
  s_add_u32 s49, s38, 4096
  buffer_load_dwordx4 v4, s[8:11], s49 offen sc1 lds
  s_add_u32 m0, s48, 6144
  s_add_u32 s49, s38, 6144
  buffer_load_dwordx4 v4, s[8:11], s49 offen sc1 lds
  s_add_u32 m0, s48, 8192
  s_add_u32 s49, s38, 8192
  buffer_load_dwordx4 v4, s[8:11], s49 offen sc1 lds
  s_add_u32 m0, s48, 10240
  s_add_u32 s49, s38, 10240
  buffer_load_dwordx4 v4, s[8:11], s49 offen sc1 lds
  s_add_u32 m0, s48, 12288
  s_add_u32 s49, s38, 12288
  buffer_load_dwordx4 v4, s[8:11], s49 offen sc1 lds
  s_add_u32 m0, s48, 14336
  s_add_u32 s49, s38, 14336
  buffer_load_dwordx4 v4, s[8:11], s49 offen sc1 lds
  s_waitcnt vmcnt(4)
  s_barrier
  ds_read_b128 v[16:19], v5 offset:0
  ds_read_b128 v[20:23], v5 offset:1024
  ds_read_b128 v[24:27], v5 offset:2048
  ds_read_b128 v[28:31], v5 offset:3072
  ds_read_b128 v[32:35], v5 offset:4096
  ds_read_b128 v[36:39], v5 offset:5120
  ds_read_b128 v[40:43], v5 offset:6144
  ds_read_b128 v[44:47], v5 offset:7168
  s_waitcnt lgkmcnt(7)
  v_mfma_f32_16x16x32_bf16 v[80:83], a[0:3], v[16:19], 0
  v_mfma_f32_16x16x32_bf16 v[84:87], a[64:67], v[16:19], 0
  v_mfma_f32_16x16x32_bf16 v[88:91], a[128:131], v[16:19], 0
  v_mfma_f32_16x16x32_bf16 v[92:95], a[192:195], v[16:19], 0
  s_waitcnt lgkmcnt(2)
  v_mfma_f32_16x16x32_bf16 v[80:83], a[4:7], v[20:23], v[80:83]
  v_mfma_f32_16x16x32_bf16 v[84:87], a[68:71], v[20:23], v[84:87]
  v_mfma_f32_16x16x32_bf16 v[88:91], a[132:135], v[20:23], v[88:91]
  v_mfma_f32_16x16x32_bf16 v[92:95], a[196:199], v[20:23], v[92:95]
  v_mfma_f32_16x16x32_bf16 v[80:83], a[8:11], v[24:27], v[80:83]
  v_mfma_f32_16x16x32_bf16 v[84:87], a[72:75], v[24:27], v[84:87]
  v_mfma_f32_16x16x32_bf16 v[88:91], a[136:139], v[24:27], v[88:91]
  v_mfma_f32_16x16x32_bf16 v[92:95], a[200:203], v[24:27], v[92:95]
  v_mfma_f32_16x16x32_bf16 v[80:83], a[12:15], v[28:31], v[80:83]
  v_mfma_f32_16x16x32_bf16 v[84:87], a[76:79], v[28:31], v[84:87]
  v_mfma_f32_16x16x32_bf16 v[88:91], a[140:143], v[28:31], v[88:91]
  v_mfma_f32_16x16x32_bf16 v[92:95], a[204:207], v[28:31], v[92:95]
  v_mfma_f32_16x16x32_bf16 v[80:83], a[16:19], v[32:35], v[80:83]
  v_mfma_f32_16x16x32_bf16 v[84:87], a[80:83], v[32:35], v[84:87]
  v_mfma_f32_16x16x32_bf16 v[88:91], a[144:147], v[32:35], v[88:91]
  v_mfma_f32_16x16x32_bf16 v[92:95], a[208:211], v[32:35], v[92:95]
  v_mfma_f32_16x16x32_bf16 v[80:83], a[20:23], v[36:39], v[80:83]
  v_mfma_f32_16x16x32_bf16 v[84:87], a[84:87], v[36:39], v[84:87]
  v_mfma_f32_16x16x32_bf16 v[88:91], a[148:151], v[36:39], v[88:91]
  v_mfma_f32_16x16x32_bf16 v[92:95], a[212:215], v[36:39], v[92:95]
  s_waitcnt lgkmcnt(0)
  v_mfma_f32_16x16x32_bf16 v[80:83], a[24:27], v[40:43], v[80:83]
  v_mfma_f32_16x16x32_bf16 v[84:87], a[88:91], v[40:43], v[84:87]
  v_mfma_f32_16x16x32_bf16 v[88:91], a[152:155], v[40:43], v[88:91]
  v_mfma_f32_16x16x32_bf16 v[92:95], a[216:219], v[40:43], v[92:95]
  v_mfma_f32_16x16x32_bf16 v[80:83], a[28:31], v[44:47], v[80:83]
  v_mfma_f32_16x16x32_bf16 v[84:87], a[92:95], v[44:47], v[84:87]
  v_mfma_f32_16x16x32_bf16 v[88:91], a[156:159], v[44:47], v[88:91]
  v_mfma_f32_16x16x32_bf16 v[92:95], a[220:223], v[44:47], v[92:95]
  s_waitcnt vmcnt(0)
  s_barrier
  ds_read_b128 v[48:51], v5 offset:8192
  ds_read_b128 v[52:55], v5 offset:9216
  ds_read_b128 v[56:59], v5 offset:10240
  ds_read_b128 v[60:63], v5 offset:11264
  ds_read_b128 v[64:67], v5 offset:12288
  ds_read_b128 v[68:71], v5 offset:13312
  ds_read_b128 v[72:75], v5 offset:14336
  ds_read_b128 v[76:79], v5 offset:15360
  s_waitcnt lgkmcnt(7)
  v_mfma_f32_16x16x32_bf16 v[80:83], a[32:35], v[48:51], v[80:83]
  v_mfma_f32_16x16x32_bf16 v[84:87], a[96:99], v[48:51], v[84:87]
  v_mfma_f32_16x16x32_bf16 v[88:91], a[160:163], v[48:51], v[88:91]
  v_mfma_f32_16x16x32_bf16 v[92:95], a[224:227], v[48:51], v[92:95]
  s_waitcnt lgkmcnt(2)
  v_mfma_f32_16x16x32_bf16 v[80:83], a[36:39], v[52:55], v[80:83]
  v_mfma_f32_16x16x32_bf16 v[84:87], a[100:103], v[52:55], v[84:87]
  v_mfma_f32_16x16x32_bf16 v[88:91], a[164:167], v[52:55], v[88:91]
  v_mfma_f32_16x16x32_bf16 v[92:95], a[228:231], v[52:55], v[92:95]
  v_mfma_f32_16x16x32_bf16 v[80:83], a[40:43], v[56:59], v[80:83]
  v_mfma_f32_16x16x32_bf16 v[84:87], a[104:107], v[56:59], v[84:87]
  v_mfma_f32_16x16x32_bf16 v[88:91], a[168:171], v[56:59], v[88:91]
  v_mfma_f32_16x16x32_bf16 v[92:95], a[232:235], v[56:59], v[92:95]
  s_cmp_lt_u32 s7, 55
  s_cbranch_scc1 hn_195
  s_lshl_b32 s58, s7, 1
  s_add_u32 s58, s58, 1
  s_add_u32 s75, s56, 0xa000
  s_cmp_lg_u32 s4, 0
  s_cbranch_scc1 sf_196
  v_mov_b32 v2, s58
  v_mov_b32 v3, 0
  s_mov_b64 exec, 1
  buffer_store_dword v2, v3, s[8:11], s75 offen sc1
  s_mov_b64 exec, -1
sf_196:
hn_195:
  v_mfma_f32_16x16x32_bf16 v[80:83], a[44:47], v[60:63], v[80:83]
  v_mfma_f32_16x16x32_bf16 v[84:87], a[108:111], v[60:63], v[84:87]
  v_mfma_f32_16x16x32_bf16 v[88:91], a[172:175], v[60:63], v[88:91]
  v_mfma_f32_16x16x32_bf16 v[92:95], a[236:239], v[60:63], v[92:95]
  v_mfma_f32_16x16x32_bf16 v[80:83], a[48:51], v[64:67], v[80:83]
  v_mfma_f32_16x16x32_bf16 v[84:87], a[112:115], v[64:67], v[84:87]
  v_mfma_f32_16x16x32_bf16 v[88:91], a[176:179], v[64:67], v[88:91]
  v_mfma_f32_16x16x32_bf16 v[92:95], a[240:243], v[64:67], v[92:95]
  v_mfma_f32_16x16x32_bf16 v[80:83], a[52:55], v[68:71], v[80:83]
  v_mfma_f32_16x16x32_bf16 v[84:87], a[116:119], v[68:71], v[84:87]
  v_mfma_f32_16x16x32_bf16 v[88:91], a[180:183], v[68:71], v[88:91]
  v_mfma_f32_16x16x32_bf16 v[92:95], a[244:247], v[68:71], v[92:95]
  s_waitcnt lgkmcnt(0)
  v_mfma_f32_16x16x32_bf16 v[80:83], a[56:59], v[72:75], v[80:83]
  v_mfma_f32_16x16x32_bf16 v[84:87], a[120:123], v[72:75], v[84:87]
  v_mfma_f32_16x16x32_bf16 v[88:91], a[184:187], v[72:75], v[88:91]
  v_mfma_f32_16x16x32_bf16 v[92:95], a[248:251], v[72:75], v[92:95]
  v_mfma_f32_16x16x32_bf16 v[80:83], a[60:63], v[76:79], v[80:83]
  v_mfma_f32_16x16x32_bf16 v[84:87], a[124:127], v[76:79], v[84:87]
  v_mfma_f32_16x16x32_bf16 v[88:91], a[188:191], v[76:79], v[88:91]
  v_mfma_f32_16x16x32_bf16 v[92:95], a[252:255], v[76:79], v[92:95]
  v_cmp_u_f32 vcc, v80, v80
  s_cbranch_vccnz Ufb_190
Ugo_191:
  v_cvt_pk_bf16_f32 v96, v80, v81
  v_lshlrev_b32 v80, 16, v96
  v_and_b32 v81, 0xffff0000, v96
  v_cvt_pk_bf16_f32 v96, v82, v83
  v_lshlrev_b32 v82, 16, v96
  v_and_b32 v83, 0xffff0000, v96
  v_cvt_pk_bf16_f32 v96, v84, v85
  v_lshlrev_b32 v84, 16, v96
  v_and_b32 v85, 0xffff0000, v96
  v_cvt_pk_bf16_f32 v96, v86, v87
  v_lshlrev_b32 v86, 16, v96
  v_and_b32 v87, 0xffff0000, v96
  v_cvt_pk_bf16_f32 v96, v88, v89
  v_lshlrev_b32 v88, 16, v96
  v_and_b32 v89, 0xffff0000, v96
  v_cvt_pk_bf16_f32 v96, v90, v91
  v_lshlrev_b32 v90, 16, v96
  v_and_b32 v91, 0xffff0000, v96
  v_cvt_pk_bf16_f32 v96, v92, v93
  v_lshlrev_b32 v92, 16, v96
  v_and_b32 v93, 0xffff0000, v96
  v_cvt_pk_bf16_f32 v96, v94, v95
  v_lshlrev_b32 v94, 16, v96
  v_and_b32 v95, 0xffff0000, v96
  v_mul_f32 v96, s41, v80
  v_mul_f32 v97, s41, v81
  v_mul_f32 v98, s41, v82
  v_mul_f32 v99, s41, v83
  v_mul_f32 v100, s41, v84
  v_mul_f32 v101, s41, v85
  v_mul_f32 v102, s41, v86
  v_mul_f32 v103, s41, v87
  v_exp_f32 v96, v96
  v_exp_f32 v97, v97
  v_exp_f32 v98, v98
  v_exp_f32 v99, v99
  v_exp_f32 v100, v100
  v_exp_f32 v101, v101
  v_exp_f32 v102, v102
  v_exp_f32 v103, v103
  v_add_f32 v96, 1.0, v96
  v_add_f32 v97, 1.0, v97
  v_add_f32 v98, 1.0, v98
  v_add_f32 v99, 1.0, v99
  v_add_f32 v100, 1.0, v100
  v_add_f32 v101, 1.0, v101
  v_add_f32 v102, 1.0, v102
  v_add_f32 v103, 1.0, v103
  v_rcp_f32 v96, v96
  v_rcp_f32 v97, v97
  v_rcp_f32 v98, v98
  v_rcp_f32 v99, v99
  v_rcp_f32 v100, v100
  v_rcp_f32 v101, v101
  v_rcp_f32 v102, v102
  v_rcp_f32 v103, v103
  v_mul_f32 v80, v80, v96
  v_mul_f32 v81, v81, v97
  v_mul_f32 v82, v82, v98
  v_mul_f32 v83, v83, v99
  v_mul_f32 v84, v84, v100
  v_mul_f32 v85, v85, v101
  v_mul_f32 v86, v86, v102
  v_mul_f32 v87, v87, v103
  v_cvt_pk_bf16_f32 v96, v80, v81
  v_lshlrev_b32 v80, 16, v96
  v_and_b32 v81, 0xffff0000, v96
  v_cvt_pk_bf16_f32 v96, v82, v83
  v_lshlrev_b32 v82, 16, v96
  v_and_b32 v83, 0xffff0000, v96
  v_cvt_pk_bf16_f32 v96, v84, v85
  v_lshlrev_b32 v84, 16, v96
  v_and_b32 v85, 0xffff0000, v96
  v_cvt_pk_bf16_f32 v96, v86, v87
  v_lshlrev_b32 v86, 16, v96
  v_and_b32 v87, 0xffff0000, v96
  v_mul_f32 v80, v80, v88
  v_mul_f32 v81, v81, v89
  v_mul_f32 v82, v82, v90
  v_mul_f32 v83, v83, v91
  v_mul_f32 v84, v84, v92
  v_mul_f32 v85, v85, v93
  v_mul_f32 v86, v86, v94
  v_mul_f32 v87, v87, v95
  v_cvt_pk_bf16_f32 v96, v80, v81
  v_cvt_pk_bf16_f32 v97, v82, v83
  v_cvt_pk_bf16_f32 v98, v84, v85
  v_cvt_pk_bf16_f32 v99, v86, v87
  buffer_store_dwordx4 v[96:99], v12, s[8:11], s39 offen sc1
  s_add_u32 s39, s39, 264192
  s_add_u32 s38, s38, 98304
  s_cmp_lt_u32 s7, 55
  s_cbranch_scc1 Uwf_197
  s_lshl_b32 s58, s7, 1
  s_add_u32 s58, s58, 1
  s_mov_b32 s59, 0
wf_198:
  buffer_load_dword v2, v13, s[8:11], s57 offen sc1
  s_waitcnt vmcnt(0)
  v_cmp_ge_u32 vcc, s58, v2
  s_cbranch_vccz wfok_199
  s_sleep 1
  s_add_u32 s59, s59, 1
  s_cmp_lt_u32 s59, s6
  s_cbranch_scc1 wf_198
  s_mov_b32 s6, 0
wfok_199:
Uwf_197:
  s_lshl_b32 s58, s7, 1
  s_add_u32 s58, s58, 2
  s_waitcnt vmcnt(0)
  s_barrier
  s_cmp_lg_u32 s4, 0
  s_cbranch_scc1 sf_200
  v_mov_b32 v2, s58
  v_mov_b32 v3, 0
  s_mov_b64 exec, 1
  buffer_store_dword v2, v3, s[8:11], s56 offen sc1
  s_mov_b64 exec, -1
sf_200:
  s_add_u32 s7, s7, 3
  s_cmp_lt_u32 s7, 64
  s_cbranch_scc1 Ul_189
  s_branch Uend_192
Ufb_190:
  s_cmp_lt_u32 s7, 55
  s_cbranch_scc1 Ugo_191
  s_lshl_b32 s58, s7, 1
  s_add_u32 s58, s58, 1
  s_mov_b32 s59, 0
wf_201:
  buffer_load_dword v2, v13, s[8:11], s57 offen sc1
  s_waitcnt vmcnt(0)
  v_cmp_ge_u32 vcc, s58, v2
  s_cbranch_vccz wfok_202
  s_sleep 1
  s_add_u32 s59, s59, 1
  s_cmp_lt_u32 s59, s6
  s_cbranch_scc1 wf_201
  s_mov_b32 s6, 0
wfok_202:
  s_lshl_b32 s49, s36, 10
  s_sub_u32 s49, s38, s49
  buffer_load_dwordx4 v[16:19], v4, s[8:11], s49 offen offset:0 sc1
  buffer_load_dwordx4 v[20:23], v4, s[8:11], s49 offen offset:1024 sc1
  buffer_load_dwordx4 v[24:27], v4, s[8:11], s49 offen offset:2048 sc1
  buffer_load_dwordx4 v[28:31], v4, s[8:11], s49 offen offset:3072 sc1
  s_add_u32 s49, s49, 4096
  buffer_load_dwordx4 v[32:35], v4, s[8:11], s49 offen offset:0 sc1
  buffer_load_dwordx4 v[36:39], v4, s[8:11], s49 offen offset:1024 sc1
  buffer_load_dwordx4 v[40:43], v4, s[8:11], s49 offen offset:2048 sc1
  buffer_load_dwordx4 v[44:47], v4, s[8:11], s49 offen offset:3072 sc1
  s_add_u32 s49, s49, 4096
  buffer_load_dwordx4 v[48:51], v4, s[8:11], s49 offen offset:0 sc1
  buffer_load_dwordx4 v[52:55], v4, s[8:11], s49 offen offset:1024 sc1
  buffer_load_dwordx4 v[56:59], v4, s[8:11], s49 offen offset:2048 sc1
  buffer_load_dwordx4 v[60:63], v4, s[8:11], s49 offen offset:3072 sc1
  s_add_u32 s49, s49, 4096
  buffer_load_dwordx4 v[64:67], v4, s[8:11], s49 offen offset:0 sc1
  buffer_load_dwordx4 v[68:71], v4, s[8:11], s49 offen offset:1024 sc1
  buffer_load_dwordx4 v[72:75], v4, s[8:11], s49 offen offset:2048 sc1
  buffer_load_dwordx4 v[76:79], v4, s[8:11], s49 offen offset:3072 sc1
  s_add_u32 s49, s49, 4096
  s_waitcnt vmcnt(0)
  v_mfma_f32_16x16x32_bf16 v[80:83], a[0:3], v[16:19], 0
  v_mfma_f32_16x16x32_bf16 v[84:87], a[64:67], v[16:19], 0
  v_mfma_f32_16x16x32_bf16 v[88:91], a[128:131], v[16:19], 0
  v_mfma_f32_16x16x32_bf16 v[92:95], a[192:195], v[16:19], 0
  v_mfma_f32_16x16x32_bf16 v[80:83], a[4:7], v[20:23], v[80:83]
  v_mfma_f32_16x16x32_bf16 v[84:87], a[68:71], v[20:23], v[84:87]
  v_mfma_f32_16x16x32_bf16 v[88:91], a[132:135], v[20:23], v[88:91]
  v_mfma_f32_16x16x32_bf16 v[92:95], a[196:199], v[20:23], v[92:95]
  v_mfma_f32_16x16x32_bf16 v[80:83], a[8:11], v[24:27], v[80:83]
  v_mfma_f32_16x16x32_bf16 v[84:87], a[72:75], v[24:27], v[84:87]
  v_mfma_f32_16x16x32_bf16 v[88:91], a[136:139], v[24:27], v[88:91]
  v_mfma_f32_16x16x32_bf16 v[92:95], a[200:203], v[24:27], v[92:95]
  v_mfma_f32_16x16x32_bf16 v[80:83], a[12:15], v[28:31], v[80:83]
  v_mfma_f32_16x16x32_bf16 v[84:87], a[76:79], v[28:31], v[84:87]
  v_mfma_f32_16x16x32_bf16 v[88:91], a[140:143], v[28:31], v[88:91]
  v_mfma_f32_16x16x32_bf16 v[92:95], a[204:207], v[28:31], v[92:95]
  v_mfma_f32_16x16x32_bf16 v[80:83], a[16:19], v[32:35], v[80:83]
  v_mfma_f32_16x16x32_bf16 v[84:87], a[80:83], v[32:35], v[84:87]
  v_mfma_f32_16x16x32_bf16 v[88:91], a[144:147], v[32:35], v[88:91]
  v_mfma_f32_16x16x32_bf16 v[92:95], a[208:211], v[32:35], v[92:95]
  v_mfma_f32_16x16x32_bf16 v[80:83], a[20:23], v[36:39], v[80:83]
  v_mfma_f32_16x16x32_bf16 v[84:87], a[84:87], v[36:39], v[84:87]
  v_mfma_f32_16x16x32_bf16 v[88:91], a[148:151], v[36:39], v[88:91]
  v_mfma_f32_16x16x32_bf16 v[92:95], a[212:215], v[36:39], v[92:95]
  v_mfma_f32_16x16x32_bf16 v[80:83], a[24:27], v[40:43], v[80:83]
  v_mfma_f32_16x16x32_bf16 v[84:87], a[88:91], v[40:43], v[84:87]
  v_mfma_f32_16x16x32_bf16 v[88:91], a[152:155], v[40:43], v[88:91]
  v_mfma_f32_16x16x32_bf16 v[92:95], a[216:219], v[40:43], v[92:95]
  v_mfma_f32_16x16x32_bf16 v[80:83], a[28:31], v[44:47], v[80:83]
  v_mfma_f32_16x16x32_bf16 v[84:87], a[92:95], v[44:47], v[84:87]
  v_mfma_f32_16x16x32_bf16 v[88:91], a[156:159], v[44:47], v[88:91]
  v_mfma_f32_16x16x32_bf16 v[92:95], a[220:223], v[44:47], v[92:95]
  v_mfma_f32_16x16x32_bf16 v[80:83], a[32:35], v[48:51], v[80:83]
  v_mfma_f32_16x16x32_bf16 v[84:87], a[96:99], v[48:51], v[84:87]
  v_mfma_f32_16x16x32_bf16 v[88:91], a[160:163], v[48:51], v[88:91]
  v_mfma_f32_16x16x32_bf16 v[92:95], a[224:227], v[48:51], v[92:95]
  v_mfma_f32_16x16x32_bf16 v[80:83], a[36:39], v[52:55], v[80:83]
  v_mfma_f32_16x16x32_bf16 v[84:87], a[100:103], v[52:55], v[84:87]
  v_mfma_f32_16x16x32_bf16 v[88:91], a[164:167], v[52:55], v[88:91]
  v_mfma_f32_16x16x32_bf16 v[92:95], a[228:231], v[52:55], v[92:95]
  v_mfma_f32_16x16x32_bf16 v[80:83], a[40:43], v[56:59], v[80:83]
  v_mfma_f32_16x16x32_bf16 v[84:87], a[104:107], v[56:59], v[84:87]
  v_mfma_f32_16x16x32_bf16 v[88:91], a[168:171], v[56:59], v[88:91]
  v_mfma_f32_16x16x32_bf16 v[92:95], a[232:235], v[56:59], v[92:95]
  v_mfma_f32_16x16x32_bf16 v[80:83], a[44:47], v[60:63], v[80:83]
  v_mfma_f32_16x16x32_bf16 v[84:87], a[108:111], v[60:63], v[84:87]
  v_mfma_f32_16x16x32_bf16 v[88:91], a[172:175], v[60:63], v[88:91]
  v_mfma_f32_16x16x32_bf16 v[92:95], a[236:239], v[60:63], v[92:95]
  v_mfma_f32_16x16x32_bf16 v[80:83], a[48:51], v[64:67], v[80:83]
  v_mfma_f32_16x16x32_bf16 v[84:87], a[112:115], v[64:67], v[84:87]
  v_mfma_f32_16x16x32_bf16 v[88:91], a[176:179], v[64:67], v[88:91]
  v_mfma_f32_16x16x32_bf16 v[92:95], a[240:243], v[64:67], v[92:95]
  v_mfma_f32_16x16x32_bf16 v[80:83], a[52:55], v[68:71], v[80:83]
  v_mfma_f32_16x16x32_bf16 v[84:87], a[116:119], v[68:71], v[84:87]
  v_mfma_f32_16x16x32_bf16 v[88:91], a[180:183], v[68:71], v[88:91]
  v_mfma_f32_16x16x32_bf16 v[92:95], a[244:247], v[68:71], v[92:95]
  v_mfma_f32_16x16x32_bf16 v[80:83], a[56:59], v[72:75], v[80:83]
  v_mfma_f32_16x16x32_bf16 v[84:87], a[120:123], v[72:75], v[84:87]
  v_mfma_f32_16x16x32_bf16 v[88:91], a[184:187], v[72:75], v[88:91]
  v_mfma_f32_16x16x32_bf16 v[92:95], a[248:251], v[72:75], v[92:95]
  v_mfma_f32_16x16x32_bf16 v[80:83], a[60:63], v[76:79], v[80:83]
  v_mfma_f32_16x16x32_bf16 v[84:87], a[124:127], v[76:79], v[84:87]
  v_mfma_f32_16x16x32_bf16 v[88:91], a[188:191], v[76:79], v[88:91]
  v_mfma_f32_16x16x32_bf16 v[92:95], a[252:255], v[76:79], v[92:95]
  s_branch Ugo_191
Uend_192:
  s_branch FIN_172
RD_171:
  s_cmp_ge_u32 s55, 30
  s_cbranch_scc1 FIN_172
  s_sub_u32 s55, s55, 22
  s_lshl_b32 s40, s55, 7
  s_add_u32 s56, s57, s40
  s_add_u32 s56, s56, 0x7209000
  s_add_u32 s57, s57, 0x7206000
  v_and_b32 v15, 31, v1
  v_lshlrev_b32 v15, 7, v15
  v_and_b32 v10, 3, v1
  v_bfe_u32 v11, v1, 2, 2
  v_lshrrev_b32 v12, 4, v1
  s_lshl_b32 s32, s4, 2
  v_add_u32 v12, s32, v12
  s_and_b32 s33, s55, 3
  s_lshl_b32 s33, s33, 2
  v_add_u32 v13, s33, v10
  v_lshl_add_u32 v14, v11, 4, v13
  v_lshlrev_b32 v14, 4, v14
  v_lshlrev_b32 v4, 4, v0
  v_add_u32 v9, 4096, v4
  v_lshl_add_u32 v5, v12, 10, v14
  v_lshlrev_b32 v6, 10, v13
  v_lshl_add_u32 v6, v12, 6, v6
  v_lshl_add_u32 v6, v11, 4, v6
  s_lshr_b32 s34, s55, 2
  s_lshl_b32 s35, s55, 16
  s_add_u32 s35, s35, 0x4000000
  s_lshl_b32 s36, s34, 14
  s_lshl_b32 s37, s4, 5
  v_lshlrev_b32 v8, 3, v10
  v_add_u32 v7, s37, v8
  s_add_u32 s39, s7, 60
  s_cmp_eq_u32 s7, 0
  s_cselect_b32 s39, 63, s39
  s_lshl_b32 s39, s39, 15
  s_add_u32 s39, s39, s36
  v_mov_b32 v16, -1
  v_mov_b32 v17, -1
  v_mov_b32 v18, -1
  v_mov_b32 v19, -1
  s_add_u32 s38, s39, 0x6000000
  buffer_store_dwordx4 v[16:19], v5, s[8:11], s38 offen sc1
  s_add_u32 s38, s39, 0x6200000
  buffer_store_dwordx4 v[16:19], v5, s[8:11], s38 offen sc1
  s_add_u32 s38, s39, 0x5fe8000
  buffer_store_dwordx4 v[16:19], v5, s[8:11], s38 offen sc1
  s_add_u32 s38, s39, 0x61e8000
  buffer_store_dwordx4 v[16:19], v5, s[8:11], s38 offen sc1
  s_add_u32 s38, s39, 0x5fd0000
  buffer_store_dwordx4 v[16:19], v5, s[8:11], s38 offen sc1
  s_add_u32 s38, s39, 0x61d0000
  buffer_store_dwordx4 v[16:19], v5, s[8:11], s38 offen sc1
  s_waitcnt vmcnt(0)
Rl_203:
  s_mov_b32 s73, 55
  s_lshl_b32 s39, s7, 15
  s_add_u32 s39, s39, s36
  buffer_load_dwordx4 v[16:19], v6, s[16:19], s39 offen
  s_cmp_lt_u32 s7, 55
  s_cselect_b32 s75, 0, 0xa000
  s_addc_u32 s58, s7, s7
  s_add_u32 s75, s75, s57
  s_cmp_lg_u32 s4, 0
  s_cbranch_scc1 wfok_209
  s_mov_b32 s59, 0
wf_208:
  buffer_load_dword v2, v15, s[8:11], s75 offen sc1
  s_waitcnt vmcnt(0)
  v_cmp_ge_u32 vcc, s58, v2
  s_cbranch_vccz wfok_209
  s_sleep 1
  s_add_u32 s59, s59, 1
  s_cmp_lt_u32 s59, s6
  s_cbranch_scc1 wf_208
  s_mov_b32 s6, 0
wfok_209:
  s_barrier
Rre_204:
  s_lshl_b32 s38, s7, 19
  s_add_u32 s38, s38, s35
  buffer_load_dwordx4 v[32:35], v4, s[8:11], s38 offen sc1
  buffer_load_dwordx4 v[36:39], v9, s[8:11], s38 offen sc1
  s_add_u32 s38, s38, 8192
  buffer_load_dwordx4 v[40:43], v4, s[8:11], s38 offen sc1
  buffer_load_dwordx4 v[44:47], v9, s[8:11], s38 offen sc1
  s_add_u32 s38, s38, 8192
  buffer_load_dwordx4 v[48:51], v4, s[8:11], s38 offen sc1
  buffer_load_dwordx4 v[52:55], v9, s[8:11], s38 offen sc1
  s_add_u32 s38, s38, 8192
  buffer_load_dwordx4 v[56:59], v4, s[8:11], s38 offen sc1
  buffer_load_dwordx4 v[60:63], v9, s[8:11], s38 offen sc1
  s_add_u32 s38, s38, 8192
  buffer_load_dwordx4 v[64:67], v4, s[8:11], s38 offen sc1
  buffer_load_dwordx4 v[68:71], v9, s[8:11], s38 offen sc1
  s_add_u32 s38, s38, 8192
  buffer_load_dwordx4 v[72:75], v4, s[8:11], s38 offen sc1
  buffer_load_dwordx4 v[76:79], v9, s[8:11], s38 offen sc1
  s_add_u32 s38, s38, 8192
  buffer_load_dwordx4 v[80:83], v4, s[8:11], s38 offen sc1
  buffer_load_dwordx4 v[84:87], v9, s[8:11], s38 offen sc1
  s_add_u32 s38, s38, 8192
  buffer_load_dwordx4 v[88:91], v4, s[8:11], s38 offen sc1
  buffer_load_dwordx4 v[92:95], v9, s[8:11], s38 offen sc1
  s_waitcnt vmcnt(16)
  v_lshlrev_b32 v20, 16, v16
  v_and_b32 v21, 0xffff0000, v16
  v_lshlrev_b32 v22, 16, v17
  v_and_b32 v23, 0xffff0000, v17
  v_lshlrev_b32 v24, 16, v18
  v_and_b32 v25, 0xffff0000, v18
  v_lshlrev_b32 v26, 16, v19
  v_and_b32 v27, 0xffff0000, v19
  s_waitcnt vmcnt(12)
  v_add_f32 v32, v32, v40
  v_add_f32 v33, v33, v41
  v_add_f32 v34, v34, v42
  v_add_f32 v35, v35, v43
  v_add_f32 v36, v36, v44
  v_add_f32 v37, v37, v45
  v_add_f32 v38, v38, v46
  v_add_f32 v39, v39, v47
  s_waitcnt vmcnt(10)
  v_add_f32 v32, v32, v48
  v_add_f32 v33, v33, v49
  v_add_f32 v34, v34, v50
  v_add_f32 v35, v35, v51
  v_add_f32 v36, v36, v52
  v_add_f32 v37, v37, v53
  v_add_f32 v38, v38, v54
  v_add_f32 v39, v39, v55
  s_waitcnt vmcnt(8)
  v_add_f32 v32, v32, v56
  v_add_f32 v33, v33, v57
  v_add_f32 v34, v34, v58
  v_add_f32 v35, v35, v59
  v_add_f32 v36, v36, v60
  v_add_f32 v37, v37, v61
  v_add_f32 v38, v38, v62
  v_add_f32 v39, v39, v63
  s_waitcnt vmcnt(6)
  v_add_f32 v32, v32, v64
  v_add_f32 v33, v33, v65
  v_add_f32 v34, v34, v66
  v_add_f32 v35, v35, v67
  v_add_f32 v36, v36, v68
  v_add_f32 v37, v37, v69
  v_add_f32 v38, v38, v70
  v_add_f32 v39, v39, v71
  s_waitcnt vmcnt(4)
  v_add_f32 v32, v32, v72
  v_add_f32 v33, v33, v73
  v_add_f32 v34, v34, v74
  v_add_f32 v35, v35, v75
  v_add_f32 v36, v36, v76
  v_add_f32 v37, v37, v77
  v_add_f32 v38, v38, v78
  v_add_f32 v39, v39, v79
  s_waitcnt vmcnt(2)
  v_add_f32 v32, v32, v80
  v_add_f32 v33, v33, v81
  v_add_f32 v34, v34, v82
  v_add_f32 v35, v35, v83
  v_add_f32 v36, v36, v84
  v_add_f32 v37, v37, v85
  v_add_f32 v38, v38, v86
  v_add_f32 v39, v39, v87
  s_waitcnt vmcnt(0)
  v_add_f32 v32, v32, v88
  v_add_f32 v33, v33, v89
  v_add_f32 v34, v34, v90
  v_add_f32 v35, v35, v91
  v_add_f32 v36, v36, v92
  v_add_f32 v37, v37, v93
  v_add_f32 v38, v38, v94
  v_add_f32 v39, v39, v95
  v_cmp_u_f32 vcc, v32, v36
  s_cbranch_vccnz Rfb_205
Rgo_206:
  v_cvt_pk_bf16_f32 v28, v32, v33
  v_lshlrev_b32 v29, 16, v28
  v_and_b32 v28, 0xffff0000, v28
  v_add_f32 v20, v20, v29
  v_add_f32 v21, v21, v28
  v_cvt_pk_bf16_f32 v40, v20, v21
  v_lshlrev_b32 v20, 16, v40
  v_and_b32 v21, 0xffff0000, v40
  v_cvt_pk_bf16_f32 v28, v34, v35
  v_lshlrev_b32 v29, 16, v28
  v_and_b32 v28, 0xffff0000, v28
  v_add_f32 v22, v22, v29
  v_add_f32 v23, v23, v28
  v_cvt_pk_bf16_f32 v41, v22, v23
  v_lshlrev_b32 v22, 16, v41
  v_and_b32 v23, 0xffff0000, v41
  v_cvt_pk_bf16_f32 v28, v36, v37
  v_lshlrev_b32 v29, 16, v28
  v_and_b32 v28, 0xffff0000, v28
  v_add_f32 v24, v24, v29
  v_add_f32 v25, v25, v28
  v_cvt_pk_bf16_f32 v42, v24, v25
  v_lshlrev_b32 v24, 16, v42
  v_and_b32 v25, 0xffff0000, v42
  v_cvt_pk_bf16_f32 v28, v38, v39
  v_lshlrev_b32 v29, 16, v28
  v_and_b32 v28, 0xffff0000, v28
  v_add_f32 v26, v26, v29
  v_add_f32 v27, v27, v28
  v_cvt_pk_bf16_f32 v43, v26, v27
  v_lshlrev_b32 v26, 16, v43
  v_and_b32 v27, 0xffff0000, v43
  s_add_u32 s38, s39, 0x6000000
  buffer_store_dwordx4 v[40:43], v5, s[8:11], s38 offen sc1
  v_add_f32 v44, v20, v21
  v_add_f32 v44, v44, v22
  v_add_f32 v44, v44, v23
  v_add_f32 v44, v44, v24
  v_add_f32 v44, v44, v25
  v_add_f32 v44, v44, v26
  v_add_f32 v44, v44, v27
  s_nop 1
  v_add_f32_dpp v44, v44, v44 row_ror:4 row_mask:0xf bank_mask:0xf
  s_nop 1
  v_add_f32_dpp v44, v44, v44 row_ror:8 row_mask:0xf bank_mask:0xf
  v_mov_b32 v46, v44
  s_nop 1
  v_permlane32_swap_b32 v44, v46
  v_add_f32 v44, v44, v46
  v_mov_b32 v46, v44
  s_nop 1
  v_permlane16_swap_b32 v44, v46
  v_add_f32 v44, v44, v46
  v_mul_f32 v44, 0x3c000000, v44
  v_mov_b32 v45, 0
  v_sub_f32 v46, v20, v44
  v_fmac_f32 v45, v46, v46
  v_sub_f32 v46, v21, v44
  v_fmac_f32 v45, v46, v46
  v_sub_f32 v46, v22, v44
  v_fmac_f32 v45, v46, v46
  v_sub_f32 v46, v23, v44
  v_fmac_f32 v45, v46, v46
  v_sub_f32 v46, v24, v44
  v_fmac_f32 v45, v46, v46
  v_sub_f32 v46, v25, v44
  v_fmac_f32 v45, v46, v46
  v_sub_f32 v46, v26, v44
  v_fmac_f32 v45, v46, v46
  v_sub_f32 v46, v27, v44
  v_fmac_f32 v45, v46, v46
  s_nop 1
  v_add_f32_dpp v45, v45, v45 row_ror:4 row_mask:0xf bank_mask:0xf
  s_nop 1
  v_add_f32_dpp v45, v45, v45 row_ror:8 row_mask:0xf bank_mask:0xf
  v_mov_b32 v46, v45
  s_nop 1
  v_permlane32_swap_b32 v45, v46
  v_add_f32 v45, v45, v46
  v_mov_b32 v46, v45
  s_nop 1
  v_permlane16_swap_b32 v45, v46
  v_add_f32 v45, v45, v46
  s_cmp_lt_u32 s7, 55
  s_cbranch_scc1 hn_210
  s_lshl_b32 s58, s7, 1
  s_add_u32 s58, s58, 1
  s_add_u32 s75, s56, 0xa000
  s_cmp_lg_u32 s4, 0
  s_cbranch_scc1 sf_211
  v_mov_b32 v2, s58
  v_mov_b32 v3, 0
  s_mov_b64 exec, 1
  buffer_store_dword v2, v3, s[8:11], s75 offen sc1
  s_mov_b64 exec, -1
sf_211:
hn_210:
  ds_write_b64 v7, v[44:45]
  s_waitcnt lgkmcnt(0)
  s_barrier
  ds_read_b64 v[48:49], v8 offset:0
  ds_read_b64 v[50:51], v8 offset:32
  ds_read_b64 v[52:53], v8 offset:64
  ds_read_b64 v[54:55], v8 offset:96
  v_xor_b32 v7, 128, v7
  v_xor_b32 v8, 128, v8
  s_waitcnt lgkmcnt(0)
  v_add_f32 v44, v48, v50
  v_add_f32 v46, v52, v54
  v_add_f32 v44, v44, v46
  v_mul_f32 v44, 0.25, v44
  v_add_f32 v45, v49, v51
  v_add_f32 v46, v53, v55
  v_add_f32 v45, v45, v46
  v_mov_b32 v47, 0
  v_sub_f32 v46, v48, v44
  v_fmac_f32 v47, v46, v46
  v_sub_f32 v46, v50, v44
  v_fmac_f32 v47, v46, v46
  v_sub_f32 v46, v52, v44
  v_fmac_f32 v47, v46, v46
  v_sub_f32 v46, v54, v44
  v_fmac_f32 v47, v46, v46
  v_mul_f32 v47, 0x43000000, v47
  v_add_f32 v45, v45, v47
  v_mul_f32 v45, 0x3b000000, v45
  v_cvt_pk_bf16_f32 v44, v44, v44
  v_lshlrev_b32 v44, 16, v44
  v_cvt_pk_bf16_f32 v45, v45, v45
  v_lshlrev_b32 v45, 16, v45
  v_add_f32 v45, 0x3727c5ac, v45
  v_cvt_pk_bf16_f32 v45, v45, v45
  v_lshlrev_b32 v45, 16, v45
  v_sqrt_f32 v45, v45
  s_nop 0
  v_cvt_pk_bf16_f32 v45, v45, v45
  v_lshlrev_b32 v45, 16, v45
  v_rcp_f32 v45, v45
  v_sub_f32 v20, v20, v44
  v_sub_f32 v21, v21, v44
  v_cvt_pk_bf16_f32 v46, v20, v21
  v_lshlrev_b32 v20, 16, v46
  v_and_b32 v21, 0xffff0000, v46
  v_mul_f32 v20, v20, v45
  v_mul_f32 v21, v21, v45
  v_cvt_pk_bf16_f32 v56, v20, v21
  v_sub_f32 v22, v22, v44
  v_sub_f32 v23, v23, v44
  v_cvt_pk_bf16_f32 v46, v22, v23
  v_lshlrev_b32 v22, 16, v46
  v_and_b32 v23, 0xffff0000, v46
  v_mul_f32 v22, v22, v45
  v_mul_f32 v23, v23, v45
  v_cvt_pk_bf16_f32 v57, v22, v23
  v_sub_f32 v24, v24, v44
  v_sub_f32 v25, v25, v44
  v_cvt_pk_bf16_f32 v46, v24, v25
  v_lshlrev_b32 v24, 16, v46
  v_and_b32 v25, 0xffff0000, v46
  v_mul_f32 v24, v24, v45
  v_mul_f32 v25, v25, v45
  v_cvt_pk_bf16_f32 v58, v24, v25
  v_sub_f32 v26, v26, v44
  v_sub_f32 v27, v27, v44
  v_cvt_pk_bf16_f32 v46, v26, v27
  v_lshlrev_b32 v26, 16, v46
  v_and_b32 v27, 0xffff0000, v46
  v_mul_f32 v26, v26, v45
  v_mul_f32 v27, v27, v45
  v_cvt_pk_bf16_f32 v59, v26, v27
  s_add_u32 s38, s39, 0x6200000
  buffer_store_dwordx4 v[56:59], v5, s[8:11], s38 offen sc1
  s_lshl_b32 s58, s7, 1
  s_add_u32 s58, s58, 2
  s_waitcnt vmcnt(0)
  s_barrier
  s_cmp_lg_u32 s4, 0
  s_cbranch_scc1 sf_212
  v_mov_b32 v2, s58
  v_mov_b32 v3, 0
  s_mov_b64 exec, 1
  buffer_store_dword v2, v3, s[8:11], s56 offen sc1
  s_mov_b64 exec, -1
sf_212:
  s_add_u32 s7, s7, 3
  s_cmp_lt_u32 s7, 64
  s_cbranch_scc1 Rl_203
  s_branch Rend_207
Rfb_205:
  s_cmp_lt_u32 s7, s73
  s_cbranch_scc1 Rgo_206
  s_mov_b32 s73, 64
  s_lshl_b32 s58, s7, 1
  s_add_u32 s58, s58, 1
  s_mov_b32 s59, 0
wf_213:
  buffer_load_dword v2, v15, s[8:11], s57 offen sc1
  s_waitcnt vmcnt(0)
  v_cmp_ge_u32 vcc, s58, v2
  s_cbranch_vccz wfok_214
  s_sleep 1
  s_add_u32 s59, s59, 1
  s_cmp_lt_u32 s59, s6
  s_cbranch_scc1 wf_213
  s_mov_b32 s6, 0
wfok_214:
  s_branch Rre_204
Rend_207:
  s_branch FIN_172
DN_170:
  s_lshr_b32 s72, s55, 4
  s_mov_b32 s7, 0
  s_and_b32 s55, s55, 15
  v_min_u32 v13, 21, v1
  v_lshlrev_b32 v13, 7, v13
  s_load_dwordx2 s[12:13], s[0:1], 80
  v_lshrrev_b32 v8, 2, v1
  v_lshlrev_b32 v8, 10, v8
  v_and_b32 v9, 3, v1
  v_lshl_add_u32 v8, v9, 4, v8
  s_mul_i32 s32, s4, 360448
  s_lshl_b32 s33, s55, 6
  s_add_u32 s32, s32, s33
  v_add_u32 v8, s32, v8
  s_mul_i32 s35, s4, 22528
  s_waitcnt lgkmcnt(0)
  s_and_b32 s13, s13, 0xffff
  s_mov_b32 s14, 0x158000
  s_mov_b32 s15, 0x20000
  s_add_u32 m0, s35, 0
  s_nop 0
  buffer_load_dwordx4 v8, s[12:15], 0 offen lds
  s_waitcnt vmcnt(3)
  v_add_u32 v8, 16384, v8
  s_add_u32 m0, s35, 1024
  s_nop 0
  buffer_load_dwordx4 v8, s[12:15], 0 offen lds
  s_waitcnt vmcnt(3)
  v_add_u32 v8, 16384, v8
  s_add_u32 m0, s35, 2048
  s_nop 0
  buffer_load_dwordx4 v8, s[12:15], 0 offen lds
  s_waitcnt vmcnt(3)
  v_add_u32 v8, 16384, v8
  s_add_u32 m0, s35, 3072
  s_nop 0
  buffer_load_dwordx4 v8, s[12:15], 0 offen lds
  s_waitcnt vmcnt(3)
  v_add_u32 v8, 16384, v8
  s_add_u32 m0, s35, 4096
  s_nop 0
  buffer_load_dwordx4 v8, s[12:15], 0 offen lds
  s_waitcnt vmcnt(3)
  v_add_u32 v8, 16384, v8
  s_add_u32 m0, s35, 5120
  s_nop 0
  buffer_load_dwordx4 v8, s[12:15], 0 offen lds
  s_waitcnt vmcnt(3)
  v_add_u32 v8, 16384, v8
  s_add_u32 m0, s35, 6144
  s_nop 0
  buffer_load_dwordx4 v8, s[12:15], 0 offen lds
  s_waitcnt vmcnt(3)
  v_add_u32 v8, 16384, v8
  s_add_u32 m0, s35, 7168
  s_nop 0
  buffer_load_dwordx4 v8, s[12:15], 0 offen lds
  s_waitcnt vmcnt(3)
  v_add_u32 v8, 16384, v8
  s_add_u32 m0, s35, 8192
  s_nop 0
  buffer_load_dwordx4 v8, s[12:15], 0 offen lds
  s_waitcnt vmcnt(3)
  v_add_u32 v8, 16384, v8
  s_add_u32 m0, s35, 9216
  s_nop 0
  buffer_load_dwordx4 v8, s[12:15], 0 offen lds
  s_waitcnt vmcnt(3)
  v_add_u32 v8, 16384, v8
  s_add_u32 m0, s35, 10240
  s_nop 0
  buffer_load_dwordx4 v8, s[12:15], 0 offen lds
  s_waitcnt vmcnt(3)
  v_add_u32 v8, 16384, v8
  s_add_u32 m0, s35, 11264
  s_nop 0
  buffer_load_dwordx4 v8, s[12:15], 0 offen lds
  s_waitcnt vmcnt(3)
  v_add_u32 v8, 16384, v8
  s_add_u32 m0, s35, 12288
  s_nop 0
  buffer_load_dwordx4 v8, s[12:15], 0 offen lds
  s_waitcnt vmcnt(3)
  v_add_u32 v8, 16384, v8
  s_add_u32 m0, s35, 13312
  s_nop 0
  buffer_load_dwordx4 v8, s[12:15], 0 offen lds
  s_waitcnt vmcnt(3)
  v_add_u32 v8, 16384, v8
  s_add_u32 m0, s35, 14336
  s_nop 0
  buffer_load_dwordx4 v8, s[12:15], 0 offen lds
  s_waitcnt vmcnt(3)
  v_add_u32 v8, 16384, v8
  s_add_u32 m0, s35, 15360
  s_nop 0
  buffer_load_dwordx4 v8, s[12:15], 0 offen lds
  s_waitcnt vmcnt(3)
  v_add_u32 v8, 16384, v8
  s_add_u32 m0, s35, 16384
  s_nop 0
  buffer_load_dwordx4 v8, s[12:15], 0 offen lds
  s_waitcnt vmcnt(3)
  v_add_u32 v8, 16384, v8
  s_add_u32 m0, s35, 17408
  s_nop 0
  buffer_load_dwordx4 v8, s[12:15], 0 offen lds
  s_waitcnt vmcnt(3)
  v_add_u32 v8, 16384, v8
  s_add_u32 m0, s35, 18432
  s_nop 0
  buffer_load_dwordx4 v8, s[12:15], 0 offen lds
  s_waitcnt vmcnt(3)
  v_add_u32 v8, 16384, v8
  s_add_u32 m0, s35, 19456
  s_nop 0
  buffer_load_dwordx4 v8, s[12:15], 0 offen lds
  s_waitcnt vmcnt(3)
  v_add_u32 v8, 16384, v8
  s_add_u32 m0, s35, 20480
  s_nop 0
  buffer_load_dwordx4 v8, s[12:15], 0 offen lds
  s_waitcnt vmcnt(3)
  v_add_u32 v8, 16384, v8
  s_add_u32 m0, s35, 21504
  s_nop 0
  buffer_load_dwordx4 v8, s[12:15], 0 offen lds
  s_waitcnt vmcnt(3)
  v_lshrrev_b32 v11, 4, v1
  v_bfe_u32 v12, v1, 2, 2
  v_lshl_add_u32 v10, v11, 3, v12
  v_lshlrev_b32 v10, 6, v10
  v_lshl_add_u32 v10, v9, 4, v10
  v_add_u32 v10, s35, v10
  s_waitcnt vmcnt(0)
  ds_read_b64_tr_b16 a[0:1], v10 offset:0
  ds_read_b64_tr_b16 a[2:3], v10 offset:256
  ds_read_b64_tr_b16 a[44:45], v10 offset:8
  ds_read_b64_tr_b16 a[46:47], v10 offset:264
  ds_read_b64_tr_b16 a[4:5], v10 offset:2048
  ds_read_b64_tr_b16 a[6:7], v10 offset:2304
  ds_read_b64_tr_b16 a[48:49], v10 offset:2056
  ds_read_b64_tr_b16 a[50:51], v10 offset:2312
  ds_read_b64_tr_b16 a[8:9], v10 offset:4096
  ds_read_b64_tr_b16 a[10:11], v10 offset:4352
  ds_read_b64_tr_b16 a[52:53], v10 offset:4104
  ds_read_b64_tr_b16 a[54:55], v10 offset:4360
  s_waitcnt lgkmcnt(4)
  ds_read_b64_tr_b16 a[12:13], v10 offset:6144
  ds_read_b64_tr_b16 a[14:15], v10 offset:6400
  ds_read_b64_tr_b16 a[56:57], v10 offset:6152
  ds_read_b64_tr_b16 a[58:59], v10 offset:6408
  ds_read_b64_tr_b16 a[16:17], v10 offset:8192
  ds_read_b64_tr_b16 a[18:19], v10 offset:8448
  ds_read_b64_tr_b16 a[60:61], v10 offset:8200
  ds_read_b64_tr_b16 a[62:63], v10 offset:8456
  ds_read_b64_tr_b16 a[20:21], v10 offset:10240
  ds_read_b64_tr_b16 a[22:23], v10 offset:10496
  ds_read_b64_tr_b16 a[64:65], v10 offset:10248
  ds_read_b64_tr_b16 a[66:67], v10 offset:10504
  s_waitcnt lgkmcnt(4)
  ds_read_b64_tr_b16 a[24:25], v10 offset:12288
  ds_read_b64_tr_b16 a[26:27], v10 offset:12544
  ds_read_b64_tr_b16 a[68:69], v10 offset:12296
  ds_read_b64_tr_b16 a[70:71], v10 offset:12552
  ds_read_b64_tr_b16 a[28:29], v10 offset:14336
  ds_read_b64_tr_b16 a[30:31], v10 offset:14592
  ds_read_b64_tr_b16 a[72:73], v10 offset:14344
  ds_read_b64_tr_b16 a[74:75], v10 offset:14600
  ds_read_b64_tr_b16 a[32:33], v10 offset:16384
  ds_read_b64_tr_b16 a[34:35], v10 offset:16640
  ds_read_b64_tr_b16 a[76:77], v10 offset:16392
  ds_read_b64_tr_b16 a[78:79], v10 offset:16648
  s_waitcnt lgkmcnt(4)
  ds_read_b64_tr_b16 a[36:37], v10 offset:18432
  ds_read_b64_tr_b16 a[38:39], v10 offset:18688
  ds_read_b64_tr_b16 a[80:81], v10 offset:18440
  ds_read_b64_tr_b16 a[82:83], v10 offset:18696
  ds_read_b64_tr_b16 a[40:41], v10 offset:20480
  ds_read_b64_tr_b16 a[42:43], v10 offset:20736
  ds_read_b64_tr_b16 a[84:85], v10 offset:20488
  ds_read_b64_tr_b16 a[86:87], v10 offset:20744
  s_waitcnt lgkmcnt(0)
  s_barrier
  v_lshlrev_b32 v4, 4, v1
  s_cmp_eq_u32 s4, 3
  s_cselect_b32 s36, 0x40000000, 0
  v_add_u32 v5, s36, v4
  s_mul_i32 s36, s4, 11264
  s_add_u32 s36, s36, 0x6400000
  s_mul_i32 s37, s72, 44032
  s_add_u32 s36, s36, s37
  s_lshl_b32 s37, s4, 11
  v_add_u32 v6, s37, v4
  v_mov_b32 v7, v4
  s_lshl_b32 s39, s72, 14
  s_lshl_b32 s40, s55, 10
  s_add_u32 s40, s40, s39
  s_add_u32 s40, s40, 0x6000000
  s_add_u32 s39, s39, s33
  v_and_b32 v12, 15, v1
  v_lshlrev_b32 v12, 10, v12
  v_lshl_add_u32 v12, v11, 4, v12
Dl_215:
  s_mul_i32 s58, s7, 43
  s_lshr_b32 s58, s58, 7
  s_mul_i32 s58, s58, 3
  s_sub_u32 s58, s7, s58
  s_lshl_b32 s57, s58, 12
  s_add_u32 s57, s57, 0x720c000
  s_cmp_lt_u32 s7, 55
  s_cselect_b32 s75, 0, 0xa000
  s_addc_u32 s74, s7, s7
  s_add_u32 s75, s75, s57
  s_mov_b32 s59, 0
wf_224:
  buffer_load_dword v2, v13, s[8:11], s75 offen sc1
  s_waitcnt vmcnt(0)
  v_cmp_ge_u32 vcc, s74, v2
  s_cbranch_vccz wfok_225
  s_sleep 1
  s_add_u32 s59, s59, 1
  s_cmp_lt_u32 s59, s6
  s_cbranch_scc1 wf_224
  s_mov_b32 s6, 0
wfok_225:
  s_mov_b32 s73, 55
Dre_217:
  s_waitcnt vmcnt(0)
  s_mul_i32 s41, s7, 88064
  s_add_u32 s41, s41, s36
  s_lshl_b32 s42, s7, 15
  s_add_u32 s42, s42, s40
  buffer_load_dwordx4 v[120:123], v4, s[8:11], s42 offen sc1
  s_add_u32 s42, s41, 0
  buffer_load_dwordx4 v[32:35], v4, s[8:11], s42 offen offset:0 sc1
  buffer_load_dwordx4 v[36:39], v4, s[8:11], s42 offen offset:1024 sc1
  buffer_load_dwordx4 v[40:43], v4, s[8:11], s42 offen offset:2048 sc1
  buffer_load_dwordx4 v[44:47], v4, s[8:11], s42 offen offset:3072 sc1
  s_add_u32 s42, s41, 4096
  buffer_load_dwordx4 v[48:51], v4, s[8:11], s42 offen offset:0 sc1
  buffer_load_dwordx4 v[52:55], v4, s[8:11], s42 offen offset:1024 sc1
  buffer_load_dwordx4 v[56:59], v4, s[8:11], s42 offen offset:2048 sc1
  buffer_load_dwordx4 v[60:63], v4, s[8:11], s42 offen offset:3072 sc1
  s_add_u32 s42, s41, 8192
  buffer_load_dwordx4 v[64:67], v4, s[8:11], s42 offen offset:0 sc1
  buffer_load_dwordx4 v[68:71], v4, s[8:11], s42 offen offset:1024 sc1
  buffer_load_dwordx4 v[72:75], v5, s[8:11], s42 offen offset:2048 sc1
  buffer_load_dword v14, v4, s[8:11], 0 offen
Dpre_222:
  s_add_u32 s44, s7, 1
  s_min_u32 s45, s44, 63
  s_mul_i32 s58, s45, 43
  s_lshr_b32 s58, s58, 7
  s_mul_i32 s58, s58, 3
  s_sub_u32 s58, s45, s58
  s_lshl_b32 s57, s58, 12
  s_add_u32 s57, s57, 0x720c000
  s_cmp_lt_u32 s45, 55
  s_cselect_b32 s75, 0, 0xa000
  s_addc_u32 s74, s45, s45
  s_add_u32 s75, s75, s57
  buffer_load_dword v15, v13, s[8:11], s75 offen sc1
  s_waitcnt vmcnt(12)
  v_mfma_f32_16x16x32_bf16 v[16:19], a[0:3], v[32:35], 0
  v_mfma_f32_16x16x32_bf16 v[20:23], a[44:47], v[32:35], 0
  v_lshlrev_b32 v96, 16, v120
  v_and_b32 v97, 0xffff0000, v120
  s_waitcnt vmcnt(11)
  v_mfma_f32_16x16x32_bf16 v[16:19], a[4:7], v[36:39], v[16:19]
  v_mfma_f32_16x16x32_bf16 v[20:23], a[48:51], v[36:39], v[20:23]
  v_lshlrev_b32 v98, 16, v121
  v_and_b32 v99, 0xffff0000, v121
  s_waitcnt vmcnt(10)
  v_mfma_f32_16x16x32_bf16 v[16:19], a[8:11], v[40:43], v[16:19]
  v_mfma_f32_16x16x32_bf16 v[20:23], a[52:55], v[40:43], v[20:23]
  v_lshlrev_b32 v100, 16, v122
  v_and_b32 v101, 0xffff0000, v122
  s_waitcnt vmcnt(9)
  v_mfma_f32_16x16x32_bf16 v[16:19], a[12:15], v[44:47], v[16:19]
  v_mfma_f32_16x16x32_bf16 v[20:23], a[56:59], v[44:47], v[20:23]
  v_lshlrev_b32 v102, 16, v123
  v_and_b32 v103, 0xffff0000, v123
  s_waitcnt vmcnt(8)
  v_mfma_f32_16x16x32_bf16 v[16:19], a[16:19], v[48:51], v[16:19]
  v_mfma_f32_16x16x32_bf16 v[20:23], a[60:63], v[48:51], v[20:23]
  s_waitcnt vmcnt(7)
  v_mfma_f32_16x16x32_bf16 v[16:19], a[20:23], v[52:55], v[16:19]
  v_mfma_f32_16x16x32_bf16 v[20:23], a[64:67], v[52:55], v[20:23]
  s_waitcnt vmcnt(6)
  v_mfma_f32_16x16x32_bf16 v[16:19], a[24:27], v[56:59], v[16:19]
  v_mfma_f32_16x16x32_bf16 v[20:23], a[68:71], v[56:59], v[20:23]
  s_waitcnt vmcnt(5)
  v_mfma_f32_16x16x32_bf16 v[16:19], a[28:31], v[60:63], v[16:19]
  v_mfma_f32_16x16x32_bf16 v[20:23], a[72:75], v[60:63], v[20:23]
  s_waitcnt vmcnt(4)
  v_mfma_f32_16x16x32_bf16 v[16:19], a[32:35], v[64:67], v[16:19]
  v_mfma_f32_16x16x32_bf16 v[20:23], a[76:79], v[64:67], v[20:23]
  s_waitcnt vmcnt(3)
  v_mfma_f32_16x16x32_bf16 v[16:19], a[36:39], v[68:71], v[16:19]
  v_mfma_f32_16x16x32_bf16 v[20:23], a[80:83], v[68:71], v[20:23]
  s_waitcnt vmcnt(2)
  v_mfma_f32_16x16x32_bf16 v[16:19], a[40:43], v[72:75], v[16:19]
  v_mfma_f32_16x16x32_bf16 v[20:23], a[84:87], v[72:75], v[20:23]
  s_nop 3
  v_cmp_u_f32 vcc, v16, v96
  s_cbranch_vccnz Dfb_218
Dgo_219:
  s_waitcnt vmcnt(0)
  v_cmp_ge_u32 vcc, s74, v15
  s_or_b32 s46, vcc_lo, vcc_hi
  s_cmp_ge_u32 s44, 64
  s_cselect_b32 s46, 1, s46
  s_cmp_lg_u32 s46, 0
  s_cbranch_scc1 Dnp_223
  s_mul_i32 s41, s44, 88064
  s_add_u32 s41, s41, s36
  s_lshl_b32 s42, s44, 15
  s_add_u32 s42, s42, s40
  buffer_load_dwordx4 v[120:123], v4, s[8:11], s42 offen sc1
  s_add_u32 s42, s41, 0
  buffer_load_dwordx4 v[32:35], v4, s[8:11], s42 offen offset:0 sc1
  buffer_load_dwordx4 v[36:39], v4, s[8:11], s42 offen offset:1024 sc1
  buffer_load_dwordx4 v[40:43], v4, s[8:11], s42 offen offset:2048 sc1
  buffer_load_dwordx4 v[44:47], v4, s[8:11], s42 offen offset:3072 sc1
  s_add_u32 s42, s41, 4096
  buffer_load_dwordx4 v[48:51], v4, s[8:11], s42 offen offset:0 sc1
  buffer_load_dwordx4 v[52:55], v4, s[8:11], s42 offen offset:1024 sc1
  buffer_load_dwordx4 v[56:59], v4, s[8:11], s42 offen offset:2048 sc1
  buffer_load_dwordx4 v[60:63], v4, s[8:11], s42 offen offset:3072 sc1
  s_add_u32 s42, s41, 8192
  buffer_load_dwordx4 v[64:67], v4, s[8:11], s42 offen offset:0 sc1
  buffer_load_dwordx4 v[68:71], v4, s[8:11], s42 offen offset:1024 sc1
  buffer_load_dwordx4 v[72:75], v5, s[8:11], s42 offen offset:2048 sc1
Dnp_223:
  s_cmp_eq_u32 s4, 3
  s_cbranch_scc1 Dw3_221
  ds_write_b128 v6, v[16:19] offset:0
  ds_write_b128 v6, v[20:23] offset:1024
  buffer_load_dword v14, v4, s[8:11], 0 offen
  s_waitcnt lgkmcnt(0)
  s_barrier
  s_branch Dsk_216
Dw3_221:
  s_barrier
  ds_read_b128 v[128:131], v7 offset:0
  ds_read_b128 v[132:135], v7 offset:1024
  ds_read_b128 v[136:139], v7 offset:2048
  ds_read_b128 v[140:143], v7 offset:3072
  ds_read_b128 v[144:147], v7 offset:4096
  ds_read_b128 v[148:151], v7 offset:5120
  s_waitcnt lgkmcnt(4)
  v_pk_add_f32 v[16:17], v[16:17], v[128:129]
  v_pk_add_f32 v[18:19], v[18:19], v[130:131]
  v_pk_add_f32 v[20:21], v[20:21], v[132:133]
  v_pk_add_f32 v[22:23], v[22:23], v[134:135]
  s_waitcnt lgkmcnt(2)
  v_pk_add_f32 v[16:17], v[16:17], v[136:137]
  v_pk_add_f32 v[18:19], v[18:19], v[138:139]
  v_pk_add_f32 v[20:21], v[20:21], v[140:141]
  v_pk_add_f32 v[22:23], v[22:23], v[142:143]
  s_waitcnt lgkmcnt(0)
  v_pk_add_f32 v[16:17], v[16:17], v[144:145]
  v_pk_add_f32 v[18:19], v[18:19], v[146:147]
  v_pk_add_f32 v[20:21], v[20:21], v[148:149]
  v_pk_add_f32 v[22:23], v[22:23], v[150:151]
  v_cvt_pk_bf16_f32 v80, v16, v17
  v_cvt_pk_bf16_f32 v81, v18, v19
  v_cvt_pk_bf16_f32 v82, v20, v21
  v_cvt_pk_bf16_f32 v83, v22, v23
  v_lshlrev_b32 v16, 16, v80
  v_and_b32 v17, 0xffff0000, v80
  v_lshlrev_b32 v18, 16, v81
  v_and_b32 v19, 0xffff0000, v81
  v_lshlrev_b32 v20, 16, v82
  v_and_b32 v21, 0xffff0000, v82
  v_lshlrev_b32 v22, 16, v83
  v_and_b32 v23, 0xffff0000, v83
  v_pk_add_f32 v[16:17], v[16:17], v[96:97]
  v_pk_add_f32 v[18:19], v[18:19], v[98:99]
  v_pk_add_f32 v[20:21], v[20:21], v[100:101]
  v_pk_add_f32 v[22:23], v[22:23], v[102:103]
  v_cvt_pk_bf16_f32 v84, v16, v17
  v_cvt_pk_bf16_f32 v85, v18, v19
  v_cvt_pk_bf16_f32 v86, v20, v21
  v_cvt_pk_bf16_f32 v87, v22, v23
  s_lshl_b32 s42, s7, 15
  s_add_u32 s42, s42, s39
  buffer_store_dwordx4 v[84:87], v12, s[20:23], s42 offen
Dsk_216:
  v_xor_b32 v6, 0x4000, v6
  v_xor_b32 v7, 0x4000, v7
  s_mov_b32 s7, s44
  s_mov_b32 s73, 55
  s_cmp_eq_u32 s46, 0
  s_cbranch_scc1 Dpre_222
  s_cmp_lt_u32 s7, 64
  s_cbranch_scc1 Dl_215
  s_branch Dend_220
Dfb_218:
  s_cmp_lt_u32 s7, s73
  s_cbranch_scc1 Dgo_219
  s_mov_b32 s73, 64
  s_mul_i32 s58, s7, 43
  s_lshr_b32 s58, s58, 7
  s_mul_i32 s58, s58, 3
  s_sub_u32 s58, s7, s58
  s_lshl_b32 s57, s58, 12
  s_add_u32 s57, s57, 0x720c000
  s_lshl_b32 s58, s7, 1
  s_add_u32 s58, s58, 1
  s_mov_b32 s59, 0
wf_226:
  buffer_load_dword v2, v13, s[8:11], s57 offen sc1
  s_waitcnt vmcnt(0)
  v_cmp_ge_u32 vcc, s58, v2
  s_cbranch_vccz wfok_227
  s_sleep 1
  s_add_u32 s59, s59, 1
  s_cmp_lt_u32 s59, s6
  s_cbranch_scc1 wf_226
  s_mov_b32 s6, 0
wfok_227:
  s_branch Dre_217
Dend_220:
  s_waitcnt lgkmcnt(0)
FIN_172:
END_1:
  s_endpgm
.section .rodata,"a"
.p2align 6
.amdhsa_kernel sequential_preLN__memory_aug_recurrent_mem_tr__glu_gated_swiglu__prompt_kernel
  .amdhsa_next_free_vgpr 512
  .amdhsa_next_free_sgpr 102
  .amdhsa_accum_offset 256
  .amdhsa_group_segment_fixed_size 0
  .amdhsa_kernarg_size 112
  .amdhsa_user_sgpr_count 2
  .amdhsa_user_sgpr_kernarg_segment_ptr 1
  .amdhsa_system_sgpr_workgroup_id_x 1
  .amdhsa_float_denorm_mode_32 3
  .amdhsa_float_denorm_mode_16_64 3
.end_amdhsa_kernel
```
